```python
import torch

def _softmax(x, axis=-1):
    return torch.softmax(x, dim=axis)
def _gelu(x):
    return torch.nn.functional.gelu(x, approximate="tanh")
def _silu(x):
    return torch.nn.functional.silu(x)
def _sigmoid(x):
    return torch.sigmoid(x)
def _layernorm(x, axis=-1, eps=1e-5):
    m = x.mean(dim=axis, keepdim=True)
    v = x.var(dim=axis, keepdim=True, unbiased=False)
    return (x - m) / torch.sqrt(v + eps)
def _scatter_add(tgt, idx, src, axis=0):
    return tgt.clone().index_add_(axis, idx, src)
def _segment_sum(src, seg, n):
    out = torch.zeros((n,) + src.shape[1:], dtype=src.dtype)
    return out.index_add_(0, seg, src)
def _pad(x, pw):
    flat = tuple(v for pair in reversed(pw) for v in pair)
    return torch.nn.functional.pad(x, flat)

kernel_name = 'gated_mix__ssm_conv_s5__glu_gated_swiglu__prompt'

def setup_inputs():

    _w = (lambda a: (lambda t: t.to(torch.bfloat16) if t.is_floating_point() else t)(torch.as_tensor(a)))
    def _A_setup():
        B, S, D = 1, 2048, 512
        P = D
        Lambda_re = -0.5 * (lambda _x: torch.exp(torch.as_tensor(_x)))((lambda *s: torch.randn(*s, dtype=torch.bfloat16) * 0.2)(P))
        Lambda_im = (lambda *s: torch.randn(*s, dtype=torch.bfloat16) * 0.4)(P) * 1.0
        B_re = (lambda *s: torch.randn(*s, dtype=torch.bfloat16) * 0.2)(P, D) * (D ** -0.5)
        B_im = (lambda *s: torch.randn(*s, dtype=torch.bfloat16) * 0.2)(P, D) * (D ** -0.5)
        C_re = (lambda *s: torch.randn(*s, dtype=torch.bfloat16) * 0.2)(D, P) * (P ** -0.5)
        C_im = (lambda *s: torch.randn(*s, dtype=torch.bfloat16) * 0.2)(D, P) * (P ** -0.5)
        log_dt = (lambda *s: torch.randn(*s, dtype=torch.bfloat16) * 0.2)(P) * 0.3 - 2.0
        Dskip = (lambda *s: torch.randn(*s, dtype=torch.bfloat16) * 0.05)(D)
        return {
            "x": _w((lambda *s: torch.randn(*s, dtype=torch.bfloat16) * 0.05)(B, S, D)),
            "Lambda_re": _w(Lambda_re),
            "Lambda_im": _w(Lambda_im),
            "B_re": _w(B_re),
            "B_im": _w(B_im),
            "C_re": _w(C_re),
            "C_im": _w(C_im),
            "log_dt": _w(log_dt),
            "Dskip": _w(Dskip),
        }
    _A_in = _A_setup()

    def _B_setup():
        B, S, D, F = 1, 2048, 512, 1376
        return {
            "x": _w((lambda *s: torch.randn(*s, dtype=torch.bfloat16) * 0.05)(B, S, D)),
            "w1": _w((lambda *s: torch.randn(*s, dtype=torch.bfloat16) * 0.8)(D, F) * (2.0 / D) ** 0.5),
            "w3": _w((lambda *s: torch.randn(*s, dtype=torch.bfloat16) * 0.8)(D, F) * (2.0 / D) ** 0.5),
            "w2": _w((lambda *s: torch.randn(*s, dtype=torch.bfloat16) * 0.8)(F, D) * (2.0 / F) ** 0.5),
        }
    _B_in = _B_setup()

    return {
        "A_x": _A_in["x"],
        "A_Lambda_re": _A_in["Lambda_re"],
        "A_Lambda_im": _A_in["Lambda_im"],
        "A_B_re": _A_in["B_re"],
        "A_B_im": _A_in["B_im"],
        "A_C_re": _A_in["C_re"],
        "A_C_im": _A_in["C_im"],
        "A_log_dt": _A_in["log_dt"],
        "A_Dskip": _A_in["Dskip"],
        "B_x": _B_in["x"],
        "B_w1": _B_in["w1"],
        "B_w3": _B_in["w3"],
        "B_w2": _B_in["w2"],
        "gate_w": _w((lambda *s: torch.randn(*s, dtype=torch.bfloat16) * 0.05)(512) * 16.0),
    }

def reference(A_x, A_Lambda_re, A_Lambda_im, A_B_re, A_B_im, A_C_re, A_C_im, A_log_dt, A_Dskip, B_x, B_w1, B_w3, B_w2, gate_w):
    def _A_ref(x, Lambda_re, Lambda_im, B_re, B_im, C_re, C_im, log_dt, Dskip):
        Bsz, L, H = x.shape
        Lam = Lambda_re + 1j * Lambda_im
        Bmat = B_re + 1j * B_im
        Cmat = C_re + 1j * C_im
        dt = torch.exp(log_dt)
        Lam_bar = torch.exp(dt * Lam)
        B_bar = ((Lam_bar - 1.0) / Lam)[:, None] * Bmat
        Bu = torch.einsum("bld,pd->blp", x + 0j, B_bar)
        h = torch.zeros_like(Bu[:, 0, :])
        hs = []
        for t in range(L):
            h = Lam_bar[None, :] * h + Bu[:, t, :]
            hs.append(h)
        hseq = torch.stack(hs, 1)
        y = 2.0 * torch.einsum("blp,dp->bld", hseq, Cmat).real + x * Dskip[None, None, :]
        return y

    def _B_ref(x, w1, w3, w2):
        gate = torch.einsum("bsd,df->bsf", x, w1)
        up = torch.einsum("bsd,df->bsf", x, w3)
        h = _silu(gate) * up
        out = torch.einsum("bsf,fd->bsd", h, w2)
        return out

    x = A_x
    g = _sigmoid((x * gate_w).sum(-1, keepdims=True))
    a = _A_ref(x, A_Lambda_re, A_Lambda_im, A_B_re, A_B_im, A_C_re, A_C_im, A_log_dt, A_Dskip)
    b = _B_ref(x, B_w1, B_w3, B_w2)
    return g * a + (1 - g) * b
```

```asm
; @launch grid=(256,1,1) block=(256,1,1) lds=163840
.amdgcn_target "amdgcn-amd-amdhsa--gfx950"
.text
.globl gated_mix__ssm_conv_s5__glu_gated_swiglu__prompt_kernel
.p2align 8
.type gated_mix__ssm_conv_s5__glu_gated_swiglu__prompt_kernel,@function
gated_mix__ssm_conv_s5__glu_gated_swiglu__prompt_kernel:
    s_cmp_ge_u32 s2, 256
    s_cbranch_scc1 L_end
    s_load_dwordx16 s[16:31], s[0:1], 0
    s_load_dwordx16 s[32:47], s[0:1], 64
    s_load_dwordx2 s[48:49], s[0:1], 128
    s_getpc_b64 s[50:51]
    s_lshr_b32 s13, s2, 3
    s_and_b32 s14, s13, 7
    s_lshl_b32 s14, s14, 12
    v_lshl_add_u32 v208, v0, 4, s14
    global_load_dwordx4 v[212:215], v208, s[50:51]
    v_lshrrev_b32 v209, 6, v0
    v_and_b32 v1, 63, v0
    v_readfirstlane_b32 s4, v209
    s_and_b32 s12, s2, 4
    s_lshl_b32 s5, s12, 1
    s_lshr_b32 s15, s2, 5
    s_add_u32 s5, s5, s15
    s_and_b32 s14, s13, 3
    s_and_b32 s11, s2, 3
    s_lshl_b32 s6, s11, 2
    s_add_u32 s6, s6, s14
    s_and_b32 s8, s2, 1
    s_and_b32 s7, s2, 2
    s_lshl_b32 s7, s7, 1
    s_add_u32 s7, s7, s14
    s_xor_b32 s7, s7, 5
    s_mul_i32 s9, s14, 2
    s_mul_i32 s15, s15, 1
    s_add_u32 s9, s9, s15
    v_lshrrev_b32 v216, 3, v1
    v_and_b32 v217, 7, v1
    v_lshrrev_b32 v218, 4, v1
    v_lshrrev_b32 v219, 5, v1
    v_xor_b32 v220, v217, v218
    v_lshlrev_b32 v220, 4, v220
    v_lshl_add_u32 v5, v216, 10, v220
    v_xor_b32 v6, 64, v5
    v_add_u32 v6, 7168, v6
    v_and_b32 v221, 3, v216
    v_lshl_add_u32 v221, v219, 4, v221
    v_lshl_add_u32 v9, v221, 10, v220
    v_xor_b32 v10, 64, v9
    v_add_u32 v10, 3072, v10
    v_add_u32 v11, 6144, v9
    v_add_u32 v12, 6144, v10
    s_lshl_b32 s96, s5, 17
    s_lshl_b32 s11, s4, 15
    s_add_u32 s96, s96, s11
    s_lshl_b32 s97, s6, 15
    s_and_b32 s11, s4, 1
    s_lshl_b32 s11, s11, 14
    s_add_u32 s97, s97, s11
    s_lshl_b32 s98, s4, 12
    s_add_u32 s98, s98, 40960
    s_lshl_b32 s99, s4, 11
    s_add_u32 s99, s99, 57344
    s_mov_b32 s54, 2097152
    s_mov_b32 s55, 0x20000
    s_mov_b32 s58, 524288
    s_mov_b32 s59, 0x20000
    s_cmp_lt_u32 s4, 2
    s_waitcnt lgkmcnt(0)
    s_mov_b32 s52, s16
    s_mov_b32 s53, s17
    s_cselect_b32 s56, s22, s24
    s_cselect_b32 s57, s23, s25
    s_add_u32 s11, s9, 0
    s_and_b32 s11, s11, 7
    s_lshl_b32 s11, s11, 7
    s_add_u32 s101, s96, s11
    s_add_u32 s3, s97, s11
    s_add_u32 m0, s98, 0
    s_nop 0
    buffer_load_dwordx4 v9, s[52:55], s101 offen offset:0 lds
    buffer_load_dwordx4 v10, s[52:55], s101 offen offset:1024 lds
    buffer_load_dwordx4 v11, s[52:55], s101 offen offset:2048 lds
    buffer_load_dwordx4 v12, s[52:55], s101 offen offset:3072 lds
    s_add_u32 m0, s99, 0
    s_nop 0
    buffer_load_dwordx4 v5, s[56:59], s3 offen offset:0 lds
    buffer_load_dwordx4 v6, s[56:59], s3 offen offset:1024 lds
    s_cmp_eq_u32 s4, 0
    s_cselect_b32 s11, s9, 0
    s_cselect_b32 s12, s42, s18
    s_cselect_b32 s13, s43, s19
    s_cselect_b32 s14, 0, 8192
    v_add_u32 v222, s11, v216
    v_and_b32 v222, 7, v222
    v_lshlrev_b32 v222, 7, v222
    s_cmp_eq_u32 s4, 2
    s_cselect_b32 s12, s20, s12
    s_cselect_b32 s13, s21, s13
    s_cmp_eq_u32 s4, 3
    s_cselect_b32 s12, s30, s12
    s_cselect_b32 s13, s31, s13
    v_lshl_add_u32 v222, v217, 4, v222
    s_lshl_b32 s11, s4, 10
    s_add_u32 m0, s14, s11
    v_and_b32 v2, 31, v1
    global_load_lds_dwordx4 v222, s[12:13]
    s_lshl_b32 s11, s6, 6
    v_lshl_add_u32 v223, v2, 1, s11
    s_load_dword s10, s[48:49], 0
    v_mov_b32 v210, 0
    v_mov_b32 v211, 0
    v_lshlrev_b32 v249, 3, v0
    ds_write_b64 v249, v[210:211] offset:1024
    v_lshlrev_b32 v3, 4, v219
    s_lshl_b32 s50, s4, 12
    s_add_u32 s50, s50, 8192
    v_bfe_u32 v228, v2, 1, 3
    v_xor_b32 v228, v228, v219
    v_lshlrev_b32 v228, 4, v228
    v_lshl_add_u32 v16, v2, 7, v228
    v_xor_b32 v17, 32, v16
    v_xor_b32 v18, 64, v16
    v_xor_b32 v19, 96, v16
    v_add_u32 v20, s50, v16
    v_add_u32 v232, 81920, v20
    v_add_u32 v236, 106496, v16
    v_add_u32 v240, 155648, v16
    v_add_u32 v16, 57344, v16
    v_add_u32 v21, s50, v17
    v_add_u32 v233, 81920, v21
    v_add_u32 v237, 106496, v17
    v_add_u32 v241, 155648, v17
    v_add_u32 v17, 57344, v17
    v_add_u32 v22, s50, v18
    v_add_u32 v234, 81920, v22
    v_add_u32 v238, 106496, v18
    v_add_u32 v242, 155648, v18
    v_add_u32 v18, 57344, v18
    v_add_u32 v23, s50, v19
    v_add_u32 v235, 81920, v23
    v_add_u32 v239, 106496, v19
    v_add_u32 v243, 155648, v19
    v_add_u32 v19, 57344, v19
    v_xor_b32 v176, 0x1000, v20
    v_xor_b32 v180, 0x1000, v232
    v_xor_b32 v177, 0x1000, v21
    v_xor_b32 v181, 0x1000, v233
    v_xor_b32 v178, 0x1000, v22
    v_xor_b32 v182, 0x1000, v234
    v_xor_b32 v179, 0x1000, v23
    v_xor_b32 v183, 0x1000, v235
    v_xor_b32 v228, v1, v218
    v_and_b32 v228, 1, v228
    v_mul_u32_u24 v228, 1056, v228
    v_add_u32 v248, v228, v3
    s_mov_b32 s60, s36
    s_mov_b32 s61, s37
    s_mov_b32 s62, 1409024
    s_mov_b32 s63, 0x20000
    s_mov_b32 s64, s38
    s_mov_b32 s65, s39
    s_mov_b32 s66, 1409024
    s_mov_b32 s67, 0x20000
    s_mov_b32 s68, s26
    s_mov_b32 s69, s27
    s_mov_b32 s70, 524288
    s_mov_b32 s71, 0x20000
    s_mov_b32 s72, s28
    s_mov_b32 s73, s29
    s_mov_b32 s74, 524288
    s_mov_b32 s75, 0x20000
    s_mov_b32 s76, s40
    s_mov_b32 s77, s41
    s_mov_b32 s78, 1409024
    s_mov_b32 s79, 0x20000
    s_mov_b32 s80, s48
    s_mov_b32 s81, s49
    s_mov_b32 s82, 11010048
    s_mov_b32 s83, 0x20000
    s_mov_b32 s88, s44
    s_mov_b32 s89, s45
    s_mov_b32 s90, 4194304
    s_mov_b32 s91, 0x20000
    s_mov_b32 s86, 8192
    s_mov_b32 s87, 0x20000
    s_mul_i32 s100, s4, 3072
    s_add_u32 s100, s100, 40960
    s_mov_b32 s22, 176128
    s_mov_b32 s23, s9
    v_lshlrev_b32 v4, 4, v1
    v_lshlrev_b32 v37, 3, v2
    s_mul_i32 s15, s4, 44032
    s_mul_i32 s12, s6, 192
    s_add_u32 s15, s15, s12
    s_mul_i32 s12, s6, 12
    s_movk_i32 s13, 2752
    v_mov_b32 v231, 0x80000000
    v_add_u32 v228, 0, v1
    v_mul_u32_u24 v229, 43691, v228
    v_lshrrev_b32 v229, 19, v229
    v_mul_u32_u24 v230, 12, v229
    v_sub_u32 v230, v228, v230
    v_mul_u32_u24 v229, s13, v229
    v_lshl_add_u32 v229, v230, 4, v229
    v_add_u32 v230, s12, v230
    v_cmp_gt_u32 vcc, 172, v230
    v_add_u32 v229, s15, v229
    s_nop 0
    v_cndmask_b32 v13, v231, v229, vcc
    v_add_u32 v228, 64, v1
    v_mul_u32_u24 v229, 43691, v228
    v_lshrrev_b32 v229, 19, v229
    v_mul_u32_u24 v230, 12, v229
    v_sub_u32 v230, v228, v230
    v_mul_u32_u24 v229, s13, v229
    v_lshl_add_u32 v229, v230, 4, v229
    v_add_u32 v230, s12, v230
    v_cmp_gt_u32 vcc, 172, v230
    v_add_u32 v229, s15, v229
    v_subrev_u32 v229, 1024, v229
    v_cndmask_b32 v14, v231, v229, vcc
    v_add_u32 v228, 128, v1
    v_mul_u32_u24 v229, 43691, v228
    v_lshrrev_b32 v229, 19, v229
    v_mul_u32_u24 v230, 12, v229
    v_sub_u32 v230, v228, v230
    v_mul_u32_u24 v229, s13, v229
    v_lshl_add_u32 v229, v230, 4, v229
    v_add_u32 v230, s12, v230
    v_cmp_gt_u32 vcc, 172, v230
    v_add_u32 v229, s15, v229
    v_subrev_u32 v229, 2048, v229
    v_cndmask_b32 v15, v231, v229, vcc
    s_cmp_eq_u32 s6, 15
    s_cbranch_scc0 L_no15
    s_lshl_b32 s12, s5, 15
    s_add_u32 s60, s26, s12
    s_addc_u32 s61, s27, 0
    s_add_u32 s64, s28, s12
    s_addc_u32 s65, s29, 0
    s_mov_b32 s62, 0x8000
    s_mov_b32 s66, 0x8000
    s_mov_b32 s23, 0
    s_movk_i32 s22, 12288
    s_mul_i32 s12, s4, 3072
    v_lshl_add_u32 v13, v1, 4, s12
    v_mov_b32 v14, v13
    v_mov_b32 v15, v13
L_no15:
    v_bfe_u32 v228, v1, 2, 2
    v_and_b32 v229, 3, v1
    v_and_b32 v230, 1, v218
    v_lshl_add_u32 v227, v219, 3, v228
    v_mul_u32_u24 v227, 192, v227
    v_lshl_add_u32 v227, v229, 3, v227
    s_and_b32 s12, s4, 1
    s_mul_i32 s13, s12, 96
    s_add_u32 s13, s13, 40960
    v_add_u32 v227, s13, v227
    s_lshl_b32 s12, s12, 6
    s_sub_u32 s13, 12320, s12
    s_add_u32 s12, s12, 12256
    v_mad_u32_u24 v24, v230, s13, v227
    v_mad_u32_u24 v25, v230, s12, v227
    s_lshl_b32 s12, s6, 13
    s_add_u32 s12, s12, 65536
    s_waitcnt lgkmcnt(0)
    s_add_u32 s11, s9, 1
    s_and_b32 s11, s11, 7
    s_lshl_b32 s11, s11, 7
    s_add_u32 s101, s96, s11
    s_add_u32 s3, s97, s11
    s_add_u32 m0, s98, 24576
    s_nop 0
    buffer_load_dwordx4 v9, s[52:55], s101 offen offset:0 lds
    buffer_load_dwordx4 v10, s[52:55], s101 offen offset:1024 lds
    buffer_load_dwordx4 v11, s[52:55], s101 offen offset:2048 lds
    buffer_load_dwordx4 v12, s[52:55], s101 offen offset:3072 lds
    s_add_u32 m0, s99, 24576
    s_nop 0
    buffer_load_dwordx4 v5, s[56:59], s3 offen offset:0 lds
    buffer_load_dwordx4 v6, s[56:59], s3 offen offset:1024 lds
    s_waitcnt vmcnt(6)
    s_barrier
    ds_read_b128 a[16:19], v176 offset:32768
    ds_read_b128 a[0:3], v20 offset:32768
    ds_read_b128 v[80:83], v16 offset:0
    ds_read_b128 v[84:87], v16 offset:4096
    ds_read_b128 v[88:91], v248 offset:0
    ds_read_b128 a[20:23], v177 offset:32768
    ds_read_b128 a[4:7], v21 offset:32768
    ds_read_b128 v[92:95], v17 offset:0
    ds_read_b128 v[96:99], v17 offset:4096
    ds_read_b128 v[100:103], v248 offset:32
    s_waitcnt lgkmcnt(5)
    v_mfma_f32_32x32x16_bf16 v[48:63], a[0:3], v[80:83], 0
    ds_read_b128 a[24:27], v178 offset:32768
    ds_read_b128 a[8:11], v22 offset:32768
    s_add_u32 s11, s9, 2
    s_and_b32 s11, s11, 7
    s_lshl_b32 s11, s11, 7
    s_add_u32 s101, s96, s11
    s_add_u32 s3, s97, s11
    s_add_u32 m0, s98, 49152
    s_nop 0
    buffer_load_dwordx4 v9, s[52:55], s101 offen offset:0 lds
    s_add_u32 s84, s48, s12
    s_addc_u32 s85, s49, 0
    s_lshl_b32 s34, s7, 16
    s_lshl_b32 s12, s4, 8
    s_add_u32 s34, s34, s12
    v_mfma_f32_32x32x16_bf16 v[64:79], a[0:3], v[84:87], 0
    ds_read_b128 v[104:107], v18 offset:0
    ds_read_b128 v[108:111], v18 offset:4096
    ds_read_b128 v[112:115], v248 offset:64
    s_mul_i32 s35, s4, 360448
    s_lshl_b32 s12, s7, 7
    s_add_u32 s35, s35, s12
    s_lshl_b32 s13, s5, 2
    v_mfma_f32_16x16x32_bf16 v[252:255], v[88:91], a[0:3], 0
    buffer_load_dwordx4 v10, s[52:55], s101 offen offset:1024 lds
    s_add_u32 s12, s13, s4
    s_mul_i32 s36, s12, 163840
    s_add_u32 s36, s36, 524288
    s_lshl_b32 s12, s8, 1
    s_waitcnt lgkmcnt(5)
    v_mfma_f32_32x32x16_bf16 v[48:63], a[4:7], v[92:95], v[48:63]
    ds_read_b128 a[28:31], v179 offset:32768
    ds_read_b128 a[12:15], v23 offset:32768
    buffer_load_dwordx4 v11, s[52:55], s101 offen offset:2048 lds
    s_add_u32 s12, s12, s13
    s_mul_i32 s37, s12, 163840
    s_add_u32 s37, s37, 524288
    s_add_u32 s38, s37, 163840
    v_mfma_f32_32x32x16_bf16 v[64:79], a[4:7], v[96:99], v[64:79]
    ds_read_b128 v[116:119], v19 offset:0
    ds_read_b128 v[120:123], v19 offset:4096
    ds_read_b128 v[124:127], v248 offset:96
    s_mov_b32 s24, 0xbfb8aa3b
    v_add_u32 v7, 14336, v5
    v_add_u32 v8, 14336, v6
    v_and_b32 v230, 1, v218
    v_mfma_f32_16x16x32_bf16 v[252:255], v[100:103], a[4:7], v[252:255]
    buffer_load_dwordx4 v12, s[52:55], s101 offen offset:3072 lds
    v_lshlrev_b32 v227, 2, v230
    v_xor_b32 v227, v227, v217
    v_lshlrev_b32 v227, 4, v227
    v_lshl_add_u32 v42, v216, 10, v227
    s_waitcnt lgkmcnt(5)
    v_mfma_f32_32x32x16_bf16 v[48:63], a[8:11], v[104:107], v[48:63]
    s_waitcnt vmcnt(4)
    s_barrier
    ds_read_b128 a[48:51], v176 offset:57344
    ds_read_b128 a[32:35], v20 offset:57344
    s_add_u32 m0, s99, 49152
    s_nop 0
    buffer_load_dwordx4 v5, s[56:59], s3 offen offset:0 lds
    v_add_u32 v43, 7168, v42
    v_add_u32 v44, 14336, v42
    v_add_u32 v45, 21504, v42
    s_sub_u32 s12, 15, s5
    v_mfma_f32_32x32x16_bf16 v[64:79], a[8:11], v[108:111], v[64:79]
    ds_read_b128 v[128:131], v16 offset:24576
    ds_read_b128 v[132:135], v16 offset:28672
    ds_read_b128 v[136:139], v248 offset:128
    s_lshl_b32 s12, s12, 9
    v_lshl_add_u32 v228, v2, 4, s12
    v_cmp_eq_u32 vcc, s4, v216
    v_lshl_add_u32 v46, v3, 6, v228
    v_mfma_f32_16x16x32_bf16 v[252:255], v[112:115], a[8:11], v[252:255]
    buffer_load_dwordx4 v6, s[56:59], s3 offen offset:1024 lds
    s_lshl_b32 s12, s4, 11
    s_add_u32 s12, s12, 512
    v_add_u32 v46, s12, v46
    v_cndmask_b32 v218, v231, v228, vcc
    s_waitcnt lgkmcnt(5)
    v_mfma_f32_32x32x16_bf16 v[48:63], a[12:15], v[116:119], v[48:63]
    ds_read_b128 a[52:55], v177 offset:57344
    ds_read_b128 a[36:39], v21 offset:57344
    s_add_u32 s11, s9, 3
    s_and_b32 s11, s11, 7
    s_lshl_b32 s11, s11, 7
    s_add_u32 s101, s96, s11
    s_add_u32 s3, s97, s11
    s_add_u32 m0, s98, 73728
    s_nop 0
    buffer_load_dwordx4 v9, s[52:55], s101 offen offset:0 lds
    s_lshl_b32 s15, s5, 1
    s_lshr_b32 s12, s4, 1
    s_add_u32 s12, s12, s15
    s_lshl_b32 s12, s12, 13
    v_mfma_f32_32x32x16_bf16 v[64:79], a[12:15], v[120:123], v[64:79]
    ds_read_b128 v[140:143], v17 offset:24576
    ds_read_b128 v[144:147], v17 offset:28672
    ds_read_b128 v[148:151], v248 offset:160
    s_and_b32 s13, s4, 1
    s_lshl_b32 s14, s6, 1
    s_add_u32 s13, s13, s14
    s_lshl_b32 s13, s13, 8
    v_mfma_f32_16x16x32_bf16 v[252:255], v[124:127], a[12:15], v[252:255]
    buffer_load_dwordx4 v10, s[52:55], s101 offen offset:1024 lds
    s_add_u32 s12, s12, s13
    s_add_u32 s12, s12, 262144
    v_lshl_add_u32 v228, v1, 2, s12
    v_cmp_gt_u32 vcc, 32, v1
    s_waitcnt lgkmcnt(5)
    v_mfma_f32_32x32x16_bf16 v[48:63], a[32:35], v[128:131], v[48:63]
    ds_read_b128 a[56:59], v178 offset:57344
    ds_read_b128 a[40:43], v22 offset:57344
    buffer_load_dwordx4 v11, s[52:55], s101 offen offset:2048 lds
    s_add_u32 s15, s15, s8
    s_lshl_b32 s15, s15, 13
    s_add_u32 s15, s15, 262144
    v_cndmask_b32 v244, v231, v228, vcc
    v_mfma_f32_32x32x16_bf16 v[64:79], a[32:35], v[132:135], v[64:79]
    ds_read_b128 v[152:155], v18 offset:24576
    ds_read_b128 v[156:159], v18 offset:28672
    ds_read_b128 v[160:163], v248 offset:192
    v_lshl_add_u32 v47, v2, 8, s15
    v_lshlrev_b32 v246, 6, v2
    v_lshl_add_u32 v246, v3, 1, v246
    v_bfe_u32 v228, v2, 1, 2
    v_mfma_f32_16x16x32_bf16 v[252:255], v[136:139], a[32:35], v[252:255]
    buffer_load_dwordx4 v12, s[52:55], s101 offen offset:3072 lds
    v_lshlrev_b32 v228, 4, v228
    v_xor_b32 v246, v228, v246
    v_add_u32 v246, s50, v246
    v_bfe_u32 v247, v1, 2, 2
    s_waitcnt lgkmcnt(5)
    v_mfma_f32_32x32x16_bf16 v[48:63], a[36:39], v[140:143], v[48:63]
    ds_read_b128 a[60:63], v179 offset:57344
    ds_read_b128 a[44:47], v23 offset:57344
    s_add_u32 m0, s99, 73728
    s_nop 0
    buffer_load_dwordx4 v5, s[56:59], s3 offen offset:0 lds
    v_lshlrev_b32 v247, 6, v247
    v_lshl_add_u32 v247, v3, 5, v247
    v_and_b32 v228, 1, v1
    v_lshl_add_u32 v247, v228, 5, v247
    v_mfma_f32_32x32x16_bf16 v[64:79], a[36:39], v[144:147], v[64:79]
    ds_read_b128 v[164:167], v19 offset:24576
    ds_read_b128 v[168:171], v19 offset:28672
    ds_read_b128 v[172:175], v248 offset:224
    v_and_b32 v228, 16, v1
    v_add_u32 v247, v228, v247
    v_and_b32 v228, 2, v1
    v_lshl_add_u32 v247, v228, 2, v247
    v_mfma_f32_16x16x32_bf16 v[252:255], v[148:151], a[36:39], v[252:255]
    buffer_load_dwordx4 v6, s[56:59], s3 offen offset:1024 lds
    v_and_b32 v228, 8, v1
    v_lshlrev_b32 v228, 1, v228
    v_xor_b32 v247, v228, v247
    v_add_u32 v247, s50, v247
    s_waitcnt lgkmcnt(5)
    v_mfma_f32_32x32x16_bf16 v[48:63], a[40:43], v[152:155], v[48:63]
    s_waitcnt vmcnt(6)
    s_barrier
    ds_read_b128 a[80:83], v180 offset:0
    ds_read_b128 a[64:67], v232 offset:0
    s_add_u32 s11, s9, 4
    s_and_b32 s11, s11, 7
    s_lshl_b32 s11, s11, 7
    s_add_u32 s101, s96, s11
    s_add_u32 s3, s97, s11
    s_add_u32 m0, s98, 98304
    s_nop 0
    buffer_load_dwordx4 v9, s[52:55], s101 offen offset:0 lds
    s_lshl_b32 s12, s4, 2
    s_sub_u32 s12, s5, s12
    v_lshrrev_b32 v38, 3, v3
    v_sub_u32 v38, s12, v38
    v_mfma_f32_32x32x16_bf16 v[64:79], a[40:43], v[156:159], v[64:79]
    ds_read_b128 v[80:83], v236 offset:0
    ds_read_b128 v[84:87], v236 offset:4096
    ds_read_b128 v[88:91], v248 offset:256
    v_max_i32 v38, 0, v38
    v_min_i32 v38, 2, v38
    v_lshlrev_b32 v38, 1, v38
    s_lshl_b32 s40, s6, 12
    v_mfma_f32_16x16x32_bf16 v[252:255], v[160:163], a[40:43], v[252:255]
    buffer_load_dwordx4 v10, s[52:55], s101 offen offset:1024 lds
    s_add_u32 s40, s40, s36
    s_mul_i32 s41, s6, 6144
    s_add_u32 s41, s41, s36
    s_and_b32 s12, s4, 1
    s_waitcnt lgkmcnt(5)
    v_mfma_f32_32x32x16_bf16 v[48:63], a[44:47], v[164:167], v[48:63]
    ds_read_b128 a[84:87], v181 offset:0
    ds_read_b128 a[68:71], v233 offset:0
    buffer_load_dwordx4 v11, s[52:55], s101 offen offset:2048 lds
    s_mul_i32 s13, s12, 3072
    s_add_u32 s16, s41, s13
    s_add_u32 s16, s16, 65536
    s_mul_i32 s12, s12, 327680
    v_mfma_f32_32x32x16_bf16 v[64:79], a[44:47], v[168:171], v[64:79]
    ds_read_b128 v[92:95], v237 offset:0
    ds_read_b128 v[96:99], v237 offset:4096
    ds_read_b128 v[100:103], v248 offset:288
    s_add_u32 s17, s16, 163840
    s_sub_u32 s17, s17, s12
    s_lshl_b32 s12, s4, 14
    s_add_u32 s26, s37, s12
    v_mfma_f32_16x16x32_bf16 v[252:255], v[172:175], a[44:47], v[252:255]
    buffer_load_dwordx4 v12, s[52:55], s101 offen offset:3072 lds
    s_add_u32 s27, s38, s12
    s_mul_i32 s12, s4, 22528
    s_add_u32 s12, s12, 65536
    s_add_u32 s28, s37, s12
    s_waitcnt lgkmcnt(5)
    v_mfma_f32_32x32x16_bf16 v[48:63], a[64:67], v[80:83], v[48:63]
    ds_read_b128 a[88:91], v182 offset:0
    ds_read_b128 a[72:75], v234 offset:0
    s_add_u32 m0, s99, 98304
    s_nop 0
    buffer_load_dwordx4 v5, s[56:59], s3 offen offset:0 lds
    s_add_u32 s29, s38, s12
    s_lshl_b32 s12, s4, 7
    v_lshl_add_u32 v250, v2, 2, s12
    s_mul_i32 s10, s10, 1664525
    v_mfma_f32_32x32x16_bf16 v[64:79], a[64:67], v[84:87], v[64:79]
    ds_read_b128 v[104:107], v238 offset:0
    ds_read_b128 v[108:111], v238 offset:4096
    ds_read_b128 v[112:115], v248 offset:320
    s_add_u32 s10, s10, 1013904223
    s_cmp_eq_u32 s10, 0
    s_cselect_b32 s10, 1013904223, s10
    v_mov_b32 v245, s10
    ds_read_u16 v224, v223 offset:9216
    ds_read_u16 v225, v223 offset:10240
    ds_read_u16 v226, v223 offset:11264
    v_mfma_f32_16x16x32_bf16 v[252:255], v[88:91], a[64:67], v[252:255]
    buffer_load_dwordx4 v6, s[56:59], s3 offen offset:1024 lds
    s_waitcnt lgkmcnt(8)
    v_mfma_f32_32x32x16_bf16 v[48:63], a[68:71], v[92:95], v[48:63]
    ds_read_b128 a[92:95], v183 offset:0
    ds_read_b128 a[76:79], v235 offset:0
    s_add_u32 s11, s9, 5
    s_and_b32 s11, s11, 7
    s_lshl_b32 s11, s11, 7
    s_add_u32 s101, s96, s11
    s_add_u32 s3, s97, s11
    s_add_u32 m0, s98, 0
    s_nop 0
    buffer_load_dwordx4 v9, s[52:55], s101 offen offset:0 lds
    v_mfma_f32_32x32x16_bf16 v[64:79], a[68:71], v[96:99], v[64:79]
    ds_read_b128 v[116:119], v239 offset:0
    ds_read_b128 v[120:123], v239 offset:4096
    ds_read_b128 v[124:127], v248 offset:352
    v_mfma_f32_16x16x32_bf16 v[252:255], v[100:103], a[68:71], v[252:255]
    buffer_load_dwordx4 v10, s[52:55], s101 offen offset:1024 lds
    s_waitcnt lgkmcnt(8)
    v_mfma_f32_32x32x16_bf16 v[48:63], a[72:75], v[104:107], v[48:63]
    s_waitcnt vmcnt(8)
    s_barrier
    ds_read_b128 a[112:115], v180 offset:24576
    ds_read_b128 a[96:99], v232 offset:24576
    buffer_load_dwordx4 v11, s[52:55], s101 offen offset:2048 lds
    v_mfma_f32_32x32x16_bf16 v[64:79], a[72:75], v[108:111], v[64:79]
    ds_read_b128 v[128:131], v236 offset:24576
    ds_read_b128 v[132:135], v236 offset:28672
    ds_read_b128 v[136:139], v248 offset:384
    v_mfma_f32_16x16x32_bf16 v[252:255], v[112:115], a[72:75], v[252:255]
    buffer_load_dwordx4 v12, s[52:55], s101 offen offset:3072 lds
    s_waitcnt lgkmcnt(5)
    v_mfma_f32_32x32x16_bf16 v[48:63], a[76:79], v[116:119], v[48:63]
    ds_read_b128 a[116:119], v181 offset:24576
    ds_read_b128 a[100:103], v233 offset:24576
    s_add_u32 m0, s99, 0
    s_nop 0
    buffer_load_dwordx4 v5, s[56:59], s3 offen offset:0 lds
    v_lshlrev_b32 v224, 16, v224
    v_lshlrev_b32 v225, 16, v225
    v_mfma_f32_32x32x16_bf16 v[64:79], a[76:79], v[120:123], v[64:79]
    ds_read_b128 v[140:143], v237 offset:24576
    ds_read_b128 v[144:147], v237 offset:28672
    ds_read_b128 v[148:151], v248 offset:416
    v_lshlrev_b32 v226, 16, v226
    v_mul_f32 v226, 0x3fb8aa3b, v226
    v_mfma_f32_16x16x32_bf16 v[252:255], v[124:127], a[76:79], v[252:255]
    buffer_load_dwordx4 v6, s[56:59], s3 offen offset:1024 lds
    v_exp_f32 v226, v226
    v_mul_f32 v210, v224, v224
    s_waitcnt lgkmcnt(5)
    v_mfma_f32_32x32x16_bf16 v[48:63], a[96:99], v[128:131], v[48:63]
    ds_read_b128 a[120:123], v182 offset:24576
    ds_read_b128 a[104:107], v234 offset:24576
    s_add_u32 s11, s9, 6
    s_and_b32 s11, s11, 7
    s_lshl_b32 s11, s11, 7
    s_add_u32 s101, s96, s11
    s_add_u32 s3, s97, s11
    s_add_u32 m0, s98, 24576
    s_nop 0
    buffer_load_dwordx4 v9, s[52:55], s101 offen offset:0 lds
    v_cvt_pk_bf16_f32 v226, v226, v226
    v_lshlrev_b32 v226, 16, v226
    v_mfma_f32_32x32x16_bf16 v[64:79], a[96:99], v[132:135], v[64:79]
    ds_read_b128 v[152:155], v238 offset:24576
    ds_read_b128 v[156:159], v238 offset:28672
    ds_read_b128 v[160:163], v248 offset:448
    v_mul_f32 v208, v226, v224
    v_mul_f32 v209, v226, v225
    v_mfma_f32_16x16x32_bf16 v[252:255], v[136:139], a[96:99], v[252:255]
    buffer_load_dwordx4 v10, s[52:55], s101 offen offset:1024 lds
    v_fma_f32 v226, v225, v225, v210
    v_rcp_f32 v226, v226
    s_waitcnt lgkmcnt(5)
    v_mfma_f32_32x32x16_bf16 v[48:63], a[100:103], v[140:143], v[48:63]
    ds_read_b128 a[124:127], v183 offset:24576
    ds_read_b128 a[108:111], v235 offset:24576
    buffer_load_dwordx4 v11, s[52:55], s101 offen offset:2048 lds
    v_mul_f32 v208, 0x3fb8aa3b, v208
    v_exp_f32 v208, v208
    v_mfma_f32_32x32x16_bf16 v[64:79], a[100:103], v[144:147], v[64:79]
    ds_read_b128 v[164:167], v239 offset:24576
    ds_read_b128 v[168:171], v239 offset:28672
    ds_read_b128 v[172:175], v248 offset:480
    v_mul_f32 v209, 0x3e22f983, v209
    v_rndne_f32 v210, v209
    v_mfma_f32_16x16x32_bf16 v[252:255], v[148:151], a[100:103], v[252:255]
    buffer_load_dwordx4 v12, s[52:55], s101 offen offset:3072 lds
    v_sub_f32 v209, v209, v210
    v_cos_f32 v210, v209
    s_waitcnt lgkmcnt(5)
    v_mfma_f32_32x32x16_bf16 v[48:63], a[104:107], v[152:155], v[48:63]
    s_waitcnt vmcnt(10)
    s_barrier
    ds_read_b128 a[144:147], v180 offset:49152
    ds_read_b128 a[128:131], v232 offset:49152
    s_add_u32 m0, s99, 24576
    s_nop 0
    buffer_load_dwordx4 v5, s[56:59], s3 offen offset:0 lds
    v_sin_f32 v211, v209
    v_add_f32 v226, v226, v226
    v_mfma_f32_32x32x16_bf16 v[64:79], a[104:107], v[156:159], v[64:79]
    ds_read_b128 v[80:83], v240 offset:0
    ds_read_b128 v[84:87], v240 offset:4096
    ds_read_b128 v[88:91], v248 offset:512
    v_mul_f32 v27, v208, v210
    v_mul_f32 v28, v208, v211
    v_mfma_f32_16x16x32_bf16 v[252:255], v[160:163], a[104:107], v[252:255]
    buffer_load_dwordx4 v6, s[56:59], s3 offen offset:1024 lds
    v_add_f32 v208, -1.0, v27
    v_mul_f32 v36, v28, v224
    s_waitcnt lgkmcnt(5)
    v_mfma_f32_32x32x16_bf16 v[48:63], a[108:111], v[164:167], v[48:63]
    ds_read_b128 a[148:151], v181 offset:49152
    ds_read_b128 a[132:135], v233 offset:49152
    s_add_u32 s11, s9, 7
    s_and_b32 s11, s11, 7
    s_lshl_b32 s11, s11, 7
    s_add_u32 s101, s96, s11
    s_add_u32 s3, s97, s11
    s_add_u32 m0, s98, 49152
    s_nop 0
    buffer_load_dwordx4 v9, s[52:55], s101 offen offset:0 lds
    v_mul_f32 v35, v208, v224
    v_fma_f32 v36, v208, v225, -v36
    v_mfma_f32_32x32x16_bf16 v[64:79], a[108:111], v[168:171], v[64:79]
    ds_read_b128 v[92:95], v241 offset:0
    ds_read_b128 v[96:99], v241 offset:4096
    ds_read_b128 v[100:103], v248 offset:544
    v_fma_f32 v35, v28, v225, v35
    v_mul_f32 v36, v36, v226
    v_mfma_f32_16x16x32_bf16 v[252:255], v[172:175], a[108:111], v[252:255]
    buffer_load_dwordx4 v10, s[52:55], s101 offen offset:1024 lds
    v_mul_f32 v35, v35, v226
    v_mul_f32 v210, v28, v28
    s_waitcnt lgkmcnt(5)
    v_mfma_f32_32x32x16_bf16 v[48:63], a[128:131], v[80:83], v[48:63]
    ds_read_b128 a[152:155], v182 offset:49152
    ds_read_b128 a[136:139], v234 offset:49152
    buffer_load_dwordx4 v11, s[52:55], s101 offen offset:2048 lds
    v_mul_f32 v211, v27, v28
    v_fma_f32 v29, v27, v27, -v210
    v_mfma_f32_32x32x16_bf16 v[64:79], a[128:131], v[84:87], v[64:79]
    ds_read_b128 v[104:107], v242 offset:0
    ds_read_b128 v[108:111], v242 offset:4096
    ds_read_b128 v[112:115], v248 offset:576
    v_add_f32 v30, v211, v211
    v_mul_f32 v210, v30, v30
    v_mfma_f32_16x16x32_bf16 v[252:255], v[88:91], a[128:131], v[252:255]
    buffer_load_dwordx4 v12, s[52:55], s101 offen offset:3072 lds
    v_mul_f32 v211, v29, v30
    v_fma_f32 v29, v29, v29, -v210
    s_waitcnt lgkmcnt(5)
    v_mfma_f32_32x32x16_bf16 v[48:63], a[132:135], v[92:95], v[48:63]
    ds_read_b128 a[156:159], v183 offset:49152
    ds_read_b128 a[140:143], v235 offset:49152
    s_add_u32 m0, s99, 49152
    s_nop 0
    buffer_load_dwordx4 v5, s[56:59], s3 offen offset:0 lds
    v_add_f32 v30, v211, v211
    v_mul_f32 v210, v30, v30
    v_mfma_f32_32x32x16_bf16 v[64:79], a[132:135], v[96:99], v[64:79]
    ds_read_b128 v[116:119], v243 offset:0
    ds_read_b128 v[120:123], v243 offset:4096
    ds_read_b128 v[124:127], v248 offset:608
    v_mul_f32 v211, v29, v30
    v_fma_f32 v29, v29, v29, -v210
    v_mfma_f32_16x16x32_bf16 v[252:255], v[100:103], a[132:135], v[252:255]
    buffer_load_dwordx4 v6, s[56:59], s3 offen offset:1024 lds
    v_add_f32 v30, v211, v211
    v_mul_f32 v210, v30, v30
    s_waitcnt lgkmcnt(5)
    v_mfma_f32_32x32x16_bf16 v[48:63], a[136:139], v[104:107], v[48:63]
    s_waitcnt vmcnt(12)
    s_barrier
    ds_read_b128 a[176:179], v176 offset:32768
    ds_read_b128 a[160:163], v20 offset:32768
    global_load_ushort v251, v223, s[32:33]
    s_mul_i32 s11, s2, 43
    v_mul_u32_u24 v26, 43, v0
    v_lshrrev_b32 v26, 8, v26
    v_add_lshl_u32 v26, v26, s11, 7
    buffer_load_dword v251, v26, s[76:79], 0 offen
    s_add_u32 s11, s23, 0
    s_and_b32 s11, s11, 7
    s_mul_i32 s101, s11, s22
    s_add_u32 m0, s100, 73728
    s_nop 0
    buffer_load_dwordx4 v13, s[60:63], s101 offen offset:0 lds
    v_mul_f32 v211, v29, v30
    v_fma_f32 v29, v29, v29, -v210
    v_mfma_f32_32x32x16_bf16 v[64:79], a[136:139], v[108:111], v[64:79]
    ds_read_b128 v[128:131], v16 offset:0
    ds_read_b128 v[132:135], v16 offset:4096
    ds_read_b128 v[136:139], v248 offset:640
    v_add_f32 v30, v211, v211
    v_mul_f32 v210, v30, v30
    v_mfma_f32_16x16x32_bf16 v[252:255], v[112:115], a[136:139], v[252:255]
    buffer_load_dwordx4 v14, s[60:63], s101 offen offset:1024 lds
    v_mul_f32 v211, v29, v30
    v_fma_f32 v31, v29, v29, -v210
    s_waitcnt lgkmcnt(5)
    v_mfma_f32_32x32x16_bf16 v[48:63], a[140:143], v[116:119], v[48:63]
    ds_read_b128 a[180:183], v177 offset:32768
    ds_read_b128 a[164:167], v21 offset:32768
    buffer_load_dwordx4 v15, s[60:63], s101 offen offset:2048 lds
    v_add_f32 v32, v211, v211
    v_mul_f32 v210, v32, v32
    v_mfma_f32_32x32x16_bf16 v[64:79], a[140:143], v[120:123], v[64:79]
    ds_read_b128 v[140:143], v17 offset:0
    ds_read_b128 v[144:147], v17 offset:4096
    ds_read_b128 v[148:151], v248 offset:672
    v_mul_f32 v211, v31, v32
    v_fma_f32 v31, v31, v31, -v210
    v_mfma_f32_16x16x32_bf16 v[252:255], v[124:127], a[140:143], v[252:255]
    s_add_u32 m0, s100, 86016
    v_xor_b32 v26, 32, v13
    buffer_load_dwordx4 v26, s[64:67], s101 offen offset:0 lds
    v_add_f32 v32, v211, v211
    v_mul_f32 v210, v32, v32
    s_waitcnt lgkmcnt(5)
    v_mfma_f32_32x32x16_bf16 v[48:63], a[160:163], v[128:131], v[48:63]
    ds_read_b128 a[184:187], v178 offset:32768
    ds_read_b128 a[168:171], v22 offset:32768
    v_xor_b32 v26, 32, v14
    buffer_load_dwordx4 v26, s[64:67], s101 offen offset:1024 lds
    v_mul_f32 v211, v31, v32
    v_fma_f32 v31, v31, v31, -v210
    v_mfma_f32_32x32x16_bf16 v[64:79], a[160:163], v[132:135], v[64:79]
    ds_read_b128 v[152:155], v18 offset:0
    ds_read_b128 v[156:159], v18 offset:4096
    ds_read_b128 v[160:163], v248 offset:704
    v_add_f32 v32, v211, v211
    v_mul_f32 v210, v32, v32
    v_mfma_f32_16x16x32_bf16 v[252:255], v[136:139], a[160:163], v[252:255]
    v_xor_b32 v26, 32, v15
    buffer_load_dwordx4 v26, s[64:67], s101 offen offset:2048 lds
    v_mul_f32 v211, v31, v32
    v_fma_f32 v33, v31, v31, -v210
    s_waitcnt lgkmcnt(5)
    v_mfma_f32_32x32x16_bf16 v[48:63], a[164:167], v[140:143], v[48:63]
    ds_read_b128 a[188:191], v179 offset:32768
    ds_read_b128 a[172:175], v23 offset:32768
    v_add_f32 v34, v211, v211
    v_mfma_f32_32x32x16_bf16 v[64:79], a[164:167], v[144:147], v[64:79]
    ds_read_b128 v[164:167], v19 offset:0
    ds_read_b128 v[168:171], v19 offset:4096
    ds_read_b128 v[172:175], v248 offset:736
    v_mfma_f32_16x16x32_bf16 v[252:255], v[148:151], a[164:167], v[252:255]
    s_waitcnt lgkmcnt(5)
    v_mfma_f32_32x32x16_bf16 v[48:63], a[168:171], v[152:155], v[48:63]
    s_waitcnt vmcnt(14)
    s_barrier
    ds_read_b128 a[208:211], v176 offset:57344
    ds_read_b128 a[192:195], v20 offset:57344
    v_mfma_f32_32x32x16_bf16 v[64:79], a[168:171], v[156:159], v[64:79]
    ds_read_b128 v[80:83], v16 offset:24576
    ds_read_b128 v[84:87], v16 offset:28672
    ds_read_b128 v[88:91], v248 offset:768
    v_mfma_f32_16x16x32_bf16 v[252:255], v[160:163], a[168:171], v[252:255]
    s_waitcnt lgkmcnt(5)
    v_mfma_f32_32x32x16_bf16 v[48:63], a[172:175], v[164:167], v[48:63]
    ds_read_b128 a[212:215], v177 offset:57344
    ds_read_b128 a[196:199], v21 offset:57344
    v_mfma_f32_32x32x16_bf16 v[64:79], a[172:175], v[168:171], v[64:79]
    ds_read_b128 v[92:95], v17 offset:24576
    ds_read_b128 v[96:99], v17 offset:28672
    ds_read_b128 v[100:103], v248 offset:800
    v_mfma_f32_16x16x32_bf16 v[252:255], v[172:175], a[172:175], v[252:255]
    s_waitcnt lgkmcnt(5)
    v_mfma_f32_32x32x16_bf16 v[48:63], a[192:195], v[80:83], v[48:63]
    ds_read_b128 a[216:219], v178 offset:57344
    ds_read_b128 a[200:203], v22 offset:57344
    v_mfma_f32_32x32x16_bf16 v[64:79], a[192:195], v[84:87], v[64:79]
    ds_read_b128 v[104:107], v18 offset:24576
    ds_read_b128 v[108:111], v18 offset:28672
    ds_read_b128 v[112:115], v248 offset:832
    v_mfma_f32_16x16x32_bf16 v[252:255], v[88:91], a[192:195], v[252:255]
    s_waitcnt lgkmcnt(5)
    v_mfma_f32_32x32x16_bf16 v[48:63], a[196:199], v[92:95], v[48:63]
    ds_read_b128 a[220:223], v179 offset:57344
    ds_read_b128 a[204:207], v23 offset:57344
    v_mfma_f32_32x32x16_bf16 v[64:79], a[196:199], v[96:99], v[64:79]
    ds_read_b128 v[116:119], v19 offset:24576
    ds_read_b128 v[120:123], v19 offset:28672
    ds_read_b128 v[124:127], v248 offset:864
    v_mfma_f32_16x16x32_bf16 v[252:255], v[100:103], a[196:199], v[252:255]
    s_waitcnt lgkmcnt(5)
    v_mfma_f32_32x32x16_bf16 v[48:63], a[200:203], v[104:107], v[48:63]
    s_waitcnt vmcnt(8)
    s_barrier
    ds_read_b128 a[240:243], v180 offset:0
    ds_read_b128 a[224:227], v232 offset:0
    v_mfma_f32_32x32x16_bf16 v[64:79], a[200:203], v[108:111], v[64:79]
    ds_read_b128 v[128:131], v236 offset:0
    ds_read_b128 v[132:135], v236 offset:4096
    ds_read_b128 v[136:139], v248 offset:896
    v_mfma_f32_16x16x32_bf16 v[252:255], v[112:115], a[200:203], v[252:255]
    s_waitcnt lgkmcnt(5)
    v_mfma_f32_32x32x16_bf16 v[48:63], a[204:207], v[116:119], v[48:63]
    ds_read_b128 a[244:247], v181 offset:0
    ds_read_b128 a[228:231], v233 offset:0
    v_mfma_f32_32x32x16_bf16 v[64:79], a[204:207], v[120:123], v[64:79]
    ds_read_b128 v[140:143], v237 offset:0
    ds_read_b128 v[144:147], v237 offset:4096
    ds_read_b128 v[148:151], v248 offset:928
    v_mfma_f32_16x16x32_bf16 v[252:255], v[124:127], a[204:207], v[252:255]
    s_waitcnt lgkmcnt(5)
    v_mfma_f32_32x32x16_bf16 v[48:63], a[224:227], v[128:131], v[48:63]
    ds_read_b128 a[248:251], v182 offset:0
    ds_read_b128 a[232:235], v234 offset:0
    v_mfma_f32_32x32x16_bf16 v[64:79], a[224:227], v[132:135], v[64:79]
    ds_read_b128 v[152:155], v238 offset:0
    ds_read_b128 v[156:159], v238 offset:4096
    ds_read_b128 v[160:163], v248 offset:960
    v_mfma_f32_16x16x32_bf16 v[252:255], v[136:139], a[224:227], v[252:255]
    s_waitcnt lgkmcnt(5)
    v_mfma_f32_32x32x16_bf16 v[48:63], a[228:231], v[140:143], v[48:63]
    ds_read_b128 a[252:255], v183 offset:0
    ds_read_b128 a[236:239], v235 offset:0
    v_mfma_f32_32x32x16_bf16 v[64:79], a[228:231], v[144:147], v[64:79]
    ds_read_b128 v[164:167], v239 offset:0
    ds_read_b128 v[168:171], v239 offset:4096
    ds_read_b128 v[172:175], v248 offset:992
    v_mfma_f32_16x16x32_bf16 v[252:255], v[148:151], a[228:231], v[252:255]
    s_waitcnt lgkmcnt(5)
    v_mfma_f32_32x32x16_bf16 v[48:63], a[232:235], v[152:155], v[48:63]
    v_mfma_f32_32x32x16_bf16 v[64:79], a[232:235], v[156:159], v[64:79]
    v_mfma_f32_16x16x32_bf16 v[252:255], v[160:163], a[232:235], v[252:255]
    s_waitcnt lgkmcnt(0)
    v_mfma_f32_32x32x16_bf16 v[48:63], a[236:239], v[164:167], v[48:63]
    v_mfma_f32_32x32x16_bf16 v[64:79], a[236:239], v[168:171], v[64:79]
    v_mfma_f32_16x16x32_bf16 v[252:255], v[172:175], a[236:239], v[252:255]
    v_xor_b32 v9, 0x80000000, v28
    v_xor_b32 v10, 0x80000000, v30
    v_mov_b32 v221, s10
    v_mov_b32 v223, s10
    s_nop 5
    v_fmac_f32 v49, v27, v48
    v_fmac_f32 v65, v27, v64
    v_and_b32 v215, 16, v1
    v_fmac_f32 v49, v9, v64
    v_fmac_f32 v65, v28, v48
    v_cmp_eq_u32 vcc, 0, v215
    v_fmac_f32 v50, v27, v49
    v_fmac_f32 v66, v27, v65
    v_xor_b32 v11, 0x80000000, v34
    v_fmac_f32 v50, v9, v65
    v_fmac_f32 v66, v28, v49
    v_bfe_u32 v212, v1, 2, 2
    v_fmac_f32 v51, v27, v50
    v_fmac_f32 v67, v27, v66
    v_cndmask_b32 v214, v253, v252, vcc
    v_fmac_f32 v51, v9, v66
    v_fmac_f32 v67, v28, v50
    v_cvt_pk_bf16_f32 v214, v214, v214
    v_fmac_f32 v52, v27, v51
    v_fmac_f32 v68, v27, v67
    v_lshlrev_b32 v214, 16, v214
    v_fmac_f32 v52, v9, v67
    v_fmac_f32 v68, v28, v51
    v_mul_f32 v214, s24, v214
    v_fmac_f32 v53, v27, v52
    v_fmac_f32 v69, v27, v68
    v_exp_f32 v214, v214
    v_fmac_f32 v53, v9, v68
    v_fmac_f32 v69, v28, v52
    v_add_f32 v214, 1.0, v214
    v_fmac_f32 v54, v27, v53
    v_fmac_f32 v70, v27, v69
    v_rcp_f32 v214, v214
    v_fmac_f32 v54, v9, v69
    v_fmac_f32 v70, v28, v53
    v_cvt_pk_bf16_f32 v214, v214, v214
    v_fmac_f32 v55, v27, v54
    v_fmac_f32 v71, v27, v70
    v_lshlrev_b32 v214, 16, v214
    v_fmac_f32 v55, v9, v70
    v_fmac_f32 v71, v28, v54
    v_sub_f32 v215, 1.0, v214
    v_fmac_f32 v56, v27, v55
    v_fmac_f32 v72, v27, v71
    v_cvt_pk_bf16_f32 v215, v215, v215
    v_fmac_f32 v56, v9, v71
    v_fmac_f32 v72, v28, v55
    v_lshlrev_b32 v215, 16, v215
    v_fmac_f32 v57, v27, v56
    v_fmac_f32 v73, v27, v72
    v_rcp_f32 v40, v215
    v_fmac_f32 v57, v9, v72
    v_fmac_f32 v73, v28, v56
    v_lshlrev_b32 v212, 7, v212
    v_fmac_f32 v58, v27, v57
    v_fmac_f32 v74, v27, v73
    v_min_f32 v40, 0x7e967699, v40
    v_fmac_f32 v58, v9, v73
    v_fmac_f32 v74, v28, v57
    v_xor_b32 v216, 128, v250
    v_fmac_f32 v59, v27, v58
    v_fmac_f32 v75, v27, v74
    v_lshl_add_u32 v212, v3, 5, v212
    v_fmac_f32 v59, v9, v74
    v_fmac_f32 v75, v28, v58
    v_and_b32 v213, 8, v1
    v_fmac_f32 v60, v27, v59
    v_fmac_f32 v76, v27, v75
    v_lshl_add_u32 v212, v213, 3, v212
    v_fmac_f32 v60, v9, v75
    v_fmac_f32 v76, v28, v59
    v_and_b32 v213, 16, v1
    v_fmac_f32 v61, v27, v60
    v_fmac_f32 v77, v27, v76
    v_lshl_add_u32 v212, v213, 1, v212
    v_fmac_f32 v61, v9, v76
    v_fmac_f32 v77, v28, v60
    v_and_b32 v213, 3, v1
    v_fmac_f32 v62, v27, v61
    v_fmac_f32 v78, v27, v77
    v_lshl_add_u32 v212, v213, 3, v212
    v_fmac_f32 v62, v9, v77
    v_fmac_f32 v78, v28, v61
    v_add_u32 v16, s50, v212
    v_fmac_f32 v63, v27, v62
    v_fmac_f32 v79, v27, v78
    v_xor_b32 v17, 64, v16
    v_fmac_f32 v63, v9, v78
    v_fmac_f32 v79, v28, v62
    v_mov_b32 v208, v35
    v_mov_b32 v210, v63
    v_mov_b32 v211, v79
    v_mov_b32 v209, v36
    ds_write_b64 v249, v[210:211] offset:3072
    ds_write_b32 v250, v214 offset:5120
    v_pk_mul_f32 v[240:241], v[64:65], v[208:209] op_sel:[0,1] op_sel_hi:[1,1]
    v_pk_mul_f32 v[242:243], v[66:67], v[208:209] op_sel:[0,1] op_sel_hi:[1,1]
    v_pk_mul_f32 v[64:65], v[64:65], v[208:209] op_sel_hi:[1,0] neg_lo:[0,1] neg_hi:[0,1]
    v_pk_mul_f32 v[66:67], v[66:67], v[208:209] op_sel_hi:[1,0] neg_lo:[0,1] neg_hi:[0,1]
    v_pk_fma_f32 v[64:65], v[48:49], v[208:209], v[64:65] op_sel:[0,1,0] op_sel_hi:[1,1,1]
    v_pk_fma_f32 v[66:67], v[50:51], v[208:209], v[66:67] op_sel:[0,1,0] op_sel_hi:[1,1,1]
    v_pk_fma_f32 v[48:49], v[48:49], v[208:209], v[240:241] op_sel_hi:[1,0,1]
    v_pk_fma_f32 v[50:51], v[50:51], v[208:209], v[242:243] op_sel_hi:[1,0,1]
    s_waitcnt lgkmcnt(0)
    s_barrier
    ds_read_b64 v[224:225], v37 offset:3072
    ds_read_b64 v[226:227], v37 offset:3328
    ds_read_b64 v[228:229], v37 offset:3584
    ds_read_b64 v[230:231], v37 offset:3840
    ds_read_b64 v[232:233], v37 offset:4096
    ds_read_b64 v[234:235], v37 offset:4352
    ds_read_b64 v[236:237], v37 offset:4608
    ds_read_b64 v[238:239], v37 offset:4864
    s_lshl_b32 s12, s4, 7
    v_add_u32 v212, s12, v3
    ds_read_b128 v[176:179], v212 offset:5120
    ds_read_b128 v[180:183], v212 offset:5152
    ds_read_b128 v[184:187], v212 offset:5184
    ds_read_b128 v[188:191], v212 offset:5216
    ds_read_b32 v41, v216 offset:5120
    v_pk_mul_f32 v[240:241], v[68:69], v[208:209] op_sel:[0,1] op_sel_hi:[1,1]
    v_pk_mul_f32 v[242:243], v[70:71], v[208:209] op_sel:[0,1] op_sel_hi:[1,1]
    v_pk_mul_f32 v[68:69], v[68:69], v[208:209] op_sel_hi:[1,0] neg_lo:[0,1] neg_hi:[0,1]
    v_pk_mul_f32 v[70:71], v[70:71], v[208:209] op_sel_hi:[1,0] neg_lo:[0,1] neg_hi:[0,1]
    v_pk_fma_f32 v[68:69], v[52:53], v[208:209], v[68:69] op_sel:[0,1,0] op_sel_hi:[1,1,1]
    v_pk_fma_f32 v[70:71], v[54:55], v[208:209], v[70:71] op_sel:[0,1,0] op_sel_hi:[1,1,1]
    v_pk_fma_f32 v[52:53], v[52:53], v[208:209], v[240:241] op_sel_hi:[1,0,1]
    v_pk_fma_f32 v[54:55], v[54:55], v[208:209], v[242:243] op_sel_hi:[1,0,1]
    v_pk_mul_f32 v[240:241], v[72:73], v[208:209] op_sel:[0,1] op_sel_hi:[1,1]
    v_pk_mul_f32 v[242:243], v[74:75], v[208:209] op_sel:[0,1] op_sel_hi:[1,1]
    v_pk_mul_f32 v[72:73], v[72:73], v[208:209] op_sel_hi:[1,0] neg_lo:[0,1] neg_hi:[0,1]
    v_pk_mul_f32 v[74:75], v[74:75], v[208:209] op_sel_hi:[1,0] neg_lo:[0,1] neg_hi:[0,1]
    v_pk_fma_f32 v[72:73], v[56:57], v[208:209], v[72:73] op_sel:[0,1,0] op_sel_hi:[1,1,1]
    v_pk_fma_f32 v[74:75], v[58:59], v[208:209], v[74:75] op_sel:[0,1,0] op_sel_hi:[1,1,1]
    v_pk_fma_f32 v[56:57], v[56:57], v[208:209], v[240:241] op_sel_hi:[1,0,1]
    v_pk_fma_f32 v[58:59], v[58:59], v[208:209], v[242:243] op_sel_hi:[1,0,1]
    v_pk_mul_f32 v[240:241], v[76:77], v[208:209] op_sel:[0,1] op_sel_hi:[1,1]
    v_pk_mul_f32 v[242:243], v[78:79], v[208:209] op_sel:[0,1] op_sel_hi:[1,1]
    v_pk_mul_f32 v[76:77], v[76:77], v[208:209] op_sel_hi:[1,0] neg_lo:[0,1] neg_hi:[0,1]
    v_pk_mul_f32 v[78:79], v[78:79], v[208:209] op_sel_hi:[1,0] neg_lo:[0,1] neg_hi:[0,1]
    v_pk_fma_f32 v[76:77], v[60:61], v[208:209], v[76:77] op_sel:[0,1,0] op_sel_hi:[1,1,1]
    v_pk_fma_f32 v[78:79], v[62:63], v[208:209], v[78:79] op_sel:[0,1,0] op_sel_hi:[1,1,1]
    v_pk_fma_f32 v[60:61], v[60:61], v[208:209], v[240:241] op_sel_hi:[1,0,1]
    v_pk_fma_f32 v[62:63], v[62:63], v[208:209], v[242:243] op_sel_hi:[1,0,1]
    s_waitcnt lgkmcnt(0)
    v_sub_f32 v41, 1.0, v41
    v_cvt_pk_bf16_f32 v41, v41, v41
    v_lshlrev_b32 v41, 16, v41
    v_rcp_f32 v41, v41
    s_nop 0
    v_min_f32 v41, 0x7e967699, v41
    v_pk_mul_f32 v[48:49], v[48:49], v[176:177]
    v_pk_mul_f32 v[64:65], v[64:65], v[176:177]
    v_pk_mul_f32 v[50:51], v[50:51], v[178:179]
    v_pk_mul_f32 v[66:67], v[66:67], v[178:179]
    v_pk_mul_f32 v[52:53], v[52:53], v[180:181]
    v_pk_mul_f32 v[68:69], v[68:69], v[180:181]
    v_pk_mul_f32 v[54:55], v[54:55], v[182:183]
    v_pk_mul_f32 v[70:71], v[70:71], v[182:183]
    v_pk_mul_f32 v[56:57], v[56:57], v[184:185]
    v_pk_mul_f32 v[72:73], v[72:73], v[184:185]
    v_pk_mul_f32 v[58:59], v[58:59], v[186:187]
    v_pk_mul_f32 v[74:75], v[74:75], v[186:187]
    v_pk_mul_f32 v[60:61], v[60:61], v[188:189]
    v_pk_mul_f32 v[76:77], v[76:77], v[188:189]
    v_pk_mul_f32 v[62:63], v[62:63], v[190:191]
    v_pk_mul_f32 v[78:79], v[78:79], v[190:191]
    v_fmac_f32 v226, v29, v224
    v_fmac_f32 v227, v29, v225
    v_fmac_f32 v226, v10, v225
    v_fmac_f32 v227, v30, v224
    v_fmac_f32 v228, v29, v226
    v_fmac_f32 v229, v29, v227
    v_fmac_f32 v228, v10, v227
    v_fmac_f32 v229, v30, v226
    v_fmac_f32 v230, v29, v228
    v_fmac_f32 v231, v29, v229
    v_fmac_f32 v230, v10, v229
    v_fmac_f32 v231, v30, v228
    v_fmac_f32 v232, v29, v230
    v_fmac_f32 v233, v29, v231
    v_fmac_f32 v232, v10, v231
    v_fmac_f32 v233, v30, v230
    v_fmac_f32 v234, v29, v232
    v_fmac_f32 v235, v29, v233
    v_fmac_f32 v234, v10, v233
    v_fmac_f32 v235, v30, v232
    v_fmac_f32 v236, v29, v234
    v_fmac_f32 v237, v29, v235
    v_fmac_f32 v236, v10, v235
    v_fmac_f32 v237, v30, v234
    v_fmac_f32 v238, v29, v236
    v_fmac_f32 v239, v29, v237
    v_fmac_f32 v238, v10, v237
    v_fmac_f32 v239, v30, v236
    v_mov_b32 v220, v238
    v_mov_b32 v222, v239
    s_add_u32 s11, s23, 1
    s_and_b32 s11, s11, 7
    s_mul_i32 s101, s11, s22
    s_add_u32 m0, s100, 98304
    s_nop 0
    buffer_load_dwordx4 v13, s[60:63], s101 offen offset:0 lds
    buffer_load_dwordx4 v14, s[60:63], s101 offen offset:1024 lds
    buffer_load_dwordx4 v15, s[60:63], s101 offen offset:2048 lds
    s_add_u32 m0, s100, 110592
    v_xor_b32 v26, 32, v13
    buffer_load_dwordx4 v26, s[64:67], s101 offen offset:0 lds
    v_xor_b32 v26, 32, v14
    buffer_load_dwordx4 v26, s[64:67], s101 offen offset:1024 lds
    v_xor_b32 v26, 32, v15
    buffer_load_dwordx4 v26, s[64:67], s101 offen offset:2048 lds
    buffer_store_dwordx4 v[220:223], v218, s[84:87], 0 offen sc1
    s_waitcnt vmcnt(7)
    s_barrier
    v_add_u32 v24, 0x12000, v24
    v_add_u32 v25, 0x12000, v25
    ds_read_b64_tr_b16 v[176:177], v24 offset:0
    ds_read_b64_tr_b16 v[178:179], v24 offset:768
    ds_read_b64_tr_b16 v[180:181], v25 offset:32
    ds_read_b64_tr_b16 v[182:183], v25 offset:800
    ds_read_b64_tr_b16 v[184:185], v24 offset:64
    ds_read_b64_tr_b16 v[186:187], v24 offset:832
    ds_read_b64_tr_b16 v[188:189], v24 offset:3072
    ds_read_b64_tr_b16 v[190:191], v24 offset:3840
    s_waitcnt lgkmcnt(6)
    v_mfma_f32_32x32x16_bf16 v[80:95], v[176:179], a[0:3], 0
    ds_read_b64_tr_b16 v[192:193], v25 offset:3104
    v_mfma_f32_32x32x16_bf16 v[96:111], v[176:179], a[16:19], 0
    ds_read_b64_tr_b16 v[194:195], v25 offset:3872
    s_add_u32 s11, s23, 2
    s_and_b32 s11, s11, 7
    s_mul_i32 s101, s11, s22
    s_add_u32 m0, s100, 24576
    s_nop 0
    buffer_load_dwordx4 v13, s[60:63], s101 offen offset:0 lds
    s_waitcnt lgkmcnt(6)
    v_mfma_f32_32x32x16_bf16 v[112:127], v[180:183], a[0:3], 0
    ds_read_b64_tr_b16 v[196:197], v24 offset:3136
    v_mfma_f32_32x32x16_bf16 v[128:143], v[180:183], a[16:19], 0
    ds_read_b64_tr_b16 v[198:199], v24 offset:3904
    buffer_load_dwordx4 v14, s[60:63], s101 offen offset:1024 lds
    s_waitcnt lgkmcnt(6)
    v_mfma_f32_32x32x16_bf16 v[144:159], v[184:187], a[0:3], 0
    ds_read_b64_tr_b16 v[200:201], v24 offset:6144
    v_mfma_f32_32x32x16_bf16 v[160:175], v[184:187], a[16:19], 0
    ds_read_b64_tr_b16 v[202:203], v24 offset:6912
    buffer_load_dwordx4 v15, s[60:63], s101 offen offset:2048 lds
    s_waitcnt lgkmcnt(6)
    v_mfma_f32_32x32x16_bf16 v[80:95], v[188:191], a[4:7], v[80:95]
    ds_read_b64_tr_b16 v[204:205], v25 offset:6176
    v_mfma_f32_32x32x16_bf16 v[96:111], v[188:191], a[20:23], v[96:111]
    ds_read_b64_tr_b16 v[206:207], v25 offset:6944
    s_add_u32 m0, s100, 36864
    v_xor_b32 v26, 32, v13
    buffer_load_dwordx4 v26, s[64:67], s101 offen offset:0 lds
    s_waitcnt lgkmcnt(6)
    v_mfma_f32_32x32x16_bf16 v[112:127], v[192:195], a[4:7], v[112:127]
    ds_read_b64_tr_b16 v[176:177], v24 offset:6208
    v_mfma_f32_32x32x16_bf16 v[128:143], v[192:195], a[20:23], v[128:143]
    ds_read_b64_tr_b16 v[178:179], v24 offset:6976
    v_xor_b32 v26, 32, v14
    buffer_load_dwordx4 v26, s[64:67], s101 offen offset:1024 lds
    s_waitcnt lgkmcnt(6)
    v_mfma_f32_32x32x16_bf16 v[144:159], v[196:199], a[4:7], v[144:159]
    ds_read_b64_tr_b16 v[180:181], v24 offset:9216
    v_mfma_f32_32x32x16_bf16 v[160:175], v[196:199], a[20:23], v[160:175]
    ds_read_b64_tr_b16 v[182:183], v24 offset:9984
    v_xor_b32 v26, 32, v15
    buffer_load_dwordx4 v26, s[64:67], s101 offen offset:2048 lds
    s_waitcnt lgkmcnt(6)
    v_mfma_f32_32x32x16_bf16 v[80:95], v[200:203], a[8:11], v[80:95]
    ds_read_b64_tr_b16 v[184:185], v25 offset:9248
    v_mfma_f32_32x32x16_bf16 v[96:111], v[200:203], a[24:27], v[96:111]
    ds_read_b64_tr_b16 v[186:187], v25 offset:10016
    s_add_u32 s11, s23, 3
    s_and_b32 s11, s11, 7
    s_mul_i32 s101, s11, s22
    s_add_u32 m0, s100, 49152
    s_nop 0
    buffer_load_dwordx4 v13, s[60:63], s101 offen offset:0 lds
    s_waitcnt lgkmcnt(6)
    v_mfma_f32_32x32x16_bf16 v[112:127], v[204:207], a[8:11], v[112:127]
    ds_read_b64_tr_b16 v[188:189], v24 offset:9280
    v_mfma_f32_32x32x16_bf16 v[128:143], v[204:207], a[24:27], v[128:143]
    ds_read_b64_tr_b16 v[190:191], v24 offset:10048
    buffer_load_dwordx4 v[224:227], v46, s[84:87], 0 offen offset:0 sc1
    s_waitcnt lgkmcnt(6)
    v_mfma_f32_32x32x16_bf16 v[144:159], v[176:179], a[8:11], v[144:159]
    s_waitcnt vmcnt(9)
    s_barrier
    ds_read_b64_tr_b16 v[192:193], v24 offset:24576
    v_mfma_f32_32x32x16_bf16 v[160:175], v[176:179], a[24:27], v[160:175]
    ds_read_b64_tr_b16 v[194:195], v24 offset:25344
    buffer_load_dwordx4 v[228:231], v46, s[84:87], 0 offen offset:512 sc1
    s_waitcnt lgkmcnt(6)
    v_mfma_f32_32x32x16_bf16 v[80:95], v[180:183], a[12:15], v[80:95]
    ds_read_b64_tr_b16 v[196:197], v25 offset:24608
    v_mfma_f32_32x32x16_bf16 v[96:111], v[180:183], a[28:31], v[96:111]
    ds_read_b64_tr_b16 v[198:199], v25 offset:25376
    buffer_load_dwordx4 v14, s[60:63], s101 offen offset:1024 lds
    s_waitcnt lgkmcnt(6)
    v_mfma_f32_32x32x16_bf16 v[112:127], v[184:187], a[12:15], v[112:127]
    ds_read_b64_tr_b16 v[200:201], v24 offset:24640
    v_mfma_f32_32x32x16_bf16 v[128:143], v[184:187], a[28:31], v[128:143]
    ds_read_b64_tr_b16 v[202:203], v24 offset:25408
    buffer_load_dwordx4 v15, s[60:63], s101 offen offset:2048 lds
    s_waitcnt lgkmcnt(6)
    v_mfma_f32_32x32x16_bf16 v[144:159], v[188:191], a[12:15], v[144:159]
    ds_read_b64_tr_b16 v[204:205], v24 offset:27648
    v_mfma_f32_32x32x16_bf16 v[160:175], v[188:191], a[28:31], v[160:175]
    ds_read_b64_tr_b16 v[206:207], v24 offset:28416
    s_add_u32 m0, s100, 61440
    v_xor_b32 v26, 32, v13
    buffer_load_dwordx4 v26, s[64:67], s101 offen offset:0 lds
    s_waitcnt lgkmcnt(6)
    v_mfma_f32_32x32x16_bf16 v[80:95], v[192:195], a[32:35], v[80:95]
    ds_read_b64_tr_b16 v[176:177], v25 offset:27680
    v_mfma_f32_32x32x16_bf16 v[96:111], v[192:195], a[48:51], v[96:111]
    ds_read_b64_tr_b16 v[178:179], v25 offset:28448
    v_xor_b32 v26, 32, v14
    buffer_load_dwordx4 v26, s[64:67], s101 offen offset:1024 lds
    s_waitcnt lgkmcnt(6)
    v_mfma_f32_32x32x16_bf16 v[112:127], v[196:199], a[32:35], v[112:127]
    ds_read_b64_tr_b16 v[180:181], v24 offset:27712
    v_mfma_f32_32x32x16_bf16 v[128:143], v[196:199], a[48:51], v[128:143]
    ds_read_b64_tr_b16 v[182:183], v24 offset:28480
    v_xor_b32 v26, 32, v15
    buffer_load_dwordx4 v26, s[64:67], s101 offen offset:2048 lds
    s_waitcnt lgkmcnt(6)
    v_mfma_f32_32x32x16_bf16 v[144:159], v[200:203], a[32:35], v[144:159]
    ds_read_b64_tr_b16 v[184:185], v24 offset:30720
    v_mfma_f32_32x32x16_bf16 v[160:175], v[200:203], a[48:51], v[160:175]
    ds_read_b64_tr_b16 v[186:187], v24 offset:31488
    s_add_u32 s51, s34, 0
    s_add_u32 m0, s50, 0
    s_nop 0
    buffer_load_dwordx4 v5, s[68:71], s51 offen offset:0 lds
    s_waitcnt lgkmcnt(6)
    v_mfma_f32_32x32x16_bf16 v[80:95], v[204:207], a[36:39], v[80:95]
    ds_read_b64_tr_b16 v[188:189], v25 offset:30752
    v_mfma_f32_32x32x16_bf16 v[96:111], v[204:207], a[52:55], v[96:111]
    ds_read_b64_tr_b16 v[190:191], v25 offset:31520
    buffer_load_dwordx4 v6, s[68:71], s51 offen offset:1024 lds
    s_waitcnt lgkmcnt(6)
    v_mfma_f32_32x32x16_bf16 v[112:127], v[176:179], a[36:39], v[112:127]
    ds_read_b64_tr_b16 v[192:193], v24 offset:30784
    v_mfma_f32_32x32x16_bf16 v[128:143], v[176:179], a[52:55], v[128:143]
    ds_read_b64_tr_b16 v[194:195], v24 offset:31552
    buffer_load_dwordx4 v7, s[68:71], s51 offen offset:2048 lds
    s_waitcnt lgkmcnt(6)
    v_mfma_f32_32x32x16_bf16 v[144:159], v[180:183], a[36:39], v[144:159]
    ds_read_b64_tr_b16 v[196:197], v24 offset:33792
    v_mfma_f32_32x32x16_bf16 v[160:175], v[180:183], a[52:55], v[160:175]
    ds_read_b64_tr_b16 v[198:199], v24 offset:34560
    buffer_load_dwordx4 v8, s[68:71], s51 offen offset:3072 lds
    s_waitcnt lgkmcnt(6)
    v_mfma_f32_32x32x16_bf16 v[80:95], v[184:187], a[40:43], v[80:95]
    ds_read_b64_tr_b16 v[200:201], v25 offset:33824
    s_mov_b32 s39, 0
    s_waitcnt vmcnt(9)
L_he_chk:
    v_mov_b32 v216, 0
    v_cmp_eq_u32 vcc, s10, v225
    v_cmp_eq_u32 s[12:13], s10, v227
    s_nop 0
    v_addc_co_u32 v216, vcc, 0, v216, vcc
    v_addc_co_u32 v216, s[12:13], 0, v216, s[12:13]
    v_cmp_eq_u32 vcc, s10, v229
    v_cmp_eq_u32 s[12:13], s10, v231
    s_nop 0
    v_addc_co_u32 v216, vcc, 0, v216, vcc
    v_addc_co_u32 v216, s[12:13], 0, v216, s[12:13]
    v_cmp_ne_u32 vcc, v216, v38
    s_nop 1
    s_cbranch_vccz L_he_ok
    s_add_u32 s39, s39, 1
    s_cmp_gt_u32 s39, 200000
    s_cbranch_scc1 L_he_ok
    s_sleep 1
    buffer_load_dwordx4 v[224:227], v46, s[84:87], 0 offen offset:0 sc1
    buffer_load_dwordx4 v[228:231], v46, s[84:87], 0 offen offset:512 sc1
    s_waitcnt vmcnt(0)
    s_branch L_he_chk
L_he_ok:
    v_fma_f32 v216, v31, v228, v224
    v_fma_f32 v217, v31, v230, v226
    v_fma_f32 v216, -v32, v230, v216
    v_fmac_f32 v217, v32, v228
    ds_write_b64 v249, v[216:217] offset:5632
    v_mfma_f32_32x32x16_bf16 v[96:111], v[184:187], a[56:59], v[96:111]
    ds_read_b64_tr_b16 v[202:203], v25 offset:34592
    s_add_u32 s51, s34, 32768
    s_add_u32 m0, s50, 16384
    s_nop 0
    buffer_load_dwordx4 v5, s[68:71], s51 offen offset:0 lds
    s_mul_i32 s12, s4, 11
    s_mul_i32 s13, s12, 43691
    s_lshr_b32 s13, s13, 17
    s_waitcnt lgkmcnt(7)
    v_mfma_f32_32x32x16_bf16 v[112:127], v[188:191], a[40:43], v[112:127]
    ds_read_b64_tr_b16 v[204:205], v24 offset:33856
    s_lshl_b32 s13, s13, 1
    s_add_u32 s12, s12, 10
    s_mul_i32 s14, s12, 43691
    s_lshr_b32 s14, s14, 17
    s_lshl_b32 s14, s14, 1
    s_add_u32 s14, s14, 1
    v_mfma_f32_32x32x16_bf16 v[128:143], v[188:191], a[56:59], v[128:143]
    ds_read_b64_tr_b16 v[206:207], v24 offset:34624
    buffer_load_dwordx4 v6, s[68:71], s51 offen offset:1024 lds
    v_max_u32 v240, s13, v2
    v_min_u32 v240, s14, v240
    v_sub_u32 v240, v240, v2
    s_waitcnt lgkmcnt(7)
    v_mfma_f32_32x32x16_bf16 v[144:159], v[192:195], a[40:43], v[144:159]
    s_waitcnt lgkmcnt(3)
    s_barrier
    v_add_u32 v24, 0xffff4000, v24
    v_add_u32 v25, 0xffff4000, v25
    ds_read_b64_tr_b16 v[176:177], v24 offset:0
    v_lshl_add_u32 v12, v240, 8, v47
    s_lshl_b32 s13, s4, 3
    v_and_b32 v240, 7, v2
    v_add_u32 v240, s13, v240
    v_sub_u32 v240, v240, v2
    v_lshl_add_u32 v38, v240, 8, v47
    v_mfma_f32_32x32x16_bf16 v[160:175], v[192:195], a[56:59], v[160:175]
    ds_read_b64_tr_b16 v[178:179], v24 offset:768
    s_add_u32 s11, s23, 4
    s_and_b32 s11, s11, 7
    s_mul_i32 s101, s11, s22
    s_add_u32 m0, s100, 73728
    s_nop 0
    buffer_load_dwordx4 v13, s[60:63], s101 offen offset:0 lds
    ds_read_b64 v[224:225], v37 offset:7424
    ds_read_b64 v[226:227], v37 offset:7168
    ds_read_b64 v[228:229], v37 offset:6912
    v_mfma_f32_32x32x16_bf16 v[80:95], v[196:199], a[44:47], v[80:95]
    ds_read_b64_tr_b16 v[180:181], v25 offset:32
    ds_read_b64 v[230:231], v37 offset:6656
    ds_read_b64 v[232:233], v37 offset:6400
    ds_read_b64 v[234:235], v37 offset:6144
    ds_read_b64 v[236:237], v37 offset:5888
    ds_read_b64 v[238:239], v37 offset:5632
    v_mfma_f32_32x32x16_bf16 v[96:111], v[196:199], a[60:63], v[96:111]
    ds_read_b64_tr_b16 v[182:183], v25 offset:800
    buffer_load_dwordx4 v14, s[60:63], s101 offen offset:1024 lds
    s_waitcnt lgkmcnt(14)
    v_mfma_f32_32x32x16_bf16 v[112:127], v[200:203], a[44:47], v[112:127]
    ds_read_b64_tr_b16 v[184:185], v24 offset:64
    v_mfma_f32_32x32x16_bf16 v[128:143], v[200:203], a[60:63], v[128:143]
    ds_read_b64_tr_b16 v[186:187], v24 offset:832
    buffer_load_dwordx4 v15, s[60:63], s101 offen offset:2048 lds
    s_waitcnt lgkmcnt(14)
    v_mfma_f32_32x32x16_bf16 v[144:159], v[204:207], a[44:47], v[144:159]
    ds_read_b64_tr_b16 v[188:189], v24 offset:3072
    v_mfma_f32_32x32x16_bf16 v[160:175], v[204:207], a[60:63], v[160:175]
    ds_read_b64_tr_b16 v[190:191], v24 offset:3840
    s_add_u32 m0, s100, 86016
    v_xor_b32 v26, 32, v13
    buffer_load_dwordx4 v26, s[64:67], s101 offen offset:0 lds
    s_waitcnt lgkmcnt(14)
    v_mfma_f32_32x32x16_bf16 v[80:95], v[176:179], a[64:67], v[80:95]
    ds_read_b64_tr_b16 v[192:193], v25 offset:3104
    v_mfma_f32_32x32x16_bf16 v[96:111], v[176:179], a[80:83], v[96:111]
    ds_read_b64_tr_b16 v[194:195], v25 offset:3872
    v_xor_b32 v26, 32, v14
    buffer_load_dwordx4 v26, s[64:67], s101 offen offset:1024 lds
    s_waitcnt lgkmcnt(6)
    v_mfma_f32_32x32x16_bf16 v[112:127], v[180:183], a[64:67], v[112:127]
    ds_read_b64_tr_b16 v[196:197], v24 offset:3136
    v_fmac_f32 v226, v33, v224
    v_fmac_f32 v227, v33, v225
    v_fmac_f32 v226, v11, v225
    v_fmac_f32 v227, v34, v224
    v_fmac_f32 v228, v33, v226
    v_fmac_f32 v229, v33, v227
    v_mfma_f32_32x32x16_bf16 v[128:143], v[180:183], a[80:83], v[128:143]
    ds_read_b64_tr_b16 v[198:199], v24 offset:3904
    v_xor_b32 v26, 32, v15
    buffer_load_dwordx4 v26, s[64:67], s101 offen offset:2048 lds
    v_fmac_f32 v228, v11, v227
    v_fmac_f32 v229, v34, v226
    v_fmac_f32 v230, v33, v228
    s_waitcnt lgkmcnt(6)
    v_mfma_f32_32x32x16_bf16 v[144:159], v[184:187], a[64:67], v[144:159]
    ds_read_b64_tr_b16 v[200:201], v24 offset:6144
    v_fmac_f32 v231, v33, v229
    v_fmac_f32 v230, v11, v229
    v_fmac_f32 v231, v34, v228
    v_fmac_f32 v232, v33, v230
    v_fmac_f32 v233, v33, v231
    v_fmac_f32 v232, v11, v231
    v_mfma_f32_32x32x16_bf16 v[160:175], v[184:187], a[80:83], v[160:175]
    ds_read_b64_tr_b16 v[202:203], v24 offset:6912
    s_add_u32 m0, s50, 16384
    s_nop 0
    buffer_load_dwordx4 v7, s[68:71], s51 offen offset:2048 lds
    v_fmac_f32 v233, v34, v230
    v_fmac_f32 v234, v33, v232
    v_fmac_f32 v235, v33, v233
    s_waitcnt lgkmcnt(6)
    v_mfma_f32_32x32x16_bf16 v[80:95], v[188:191], a[68:71], v[80:95]
    ds_read_b64_tr_b16 v[204:205], v25 offset:6176
    v_fmac_f32 v234, v11, v233
    v_fmac_f32 v235, v34, v232
    v_fmac_f32 v236, v33, v234
    v_fmac_f32 v237, v33, v235
    v_fmac_f32 v236, v11, v235
    v_fmac_f32 v237, v34, v234
    v_mfma_f32_32x32x16_bf16 v[96:111], v[188:191], a[84:87], v[96:111]
    ds_read_b64_tr_b16 v[206:207], v25 offset:6944
    s_waitcnt vmcnt(9)
    ds_read_b128 a[0:3], v20 offset:0
    ds_read_b128 a[4:7], v21 offset:0
    ds_read_b128 a[8:11], v22 offset:0
    ds_read_b128 a[12:15], v23 offset:0
    buffer_load_dwordx4 v8, s[68:71], s51 offen offset:3072 lds
    v_fmac_f32 v238, v33, v236
    v_fmac_f32 v239, v33, v237
    v_fmac_f32 v238, v11, v237
    s_waitcnt lgkmcnt(10)
    v_mfma_f32_32x32x16_bf16 v[112:127], v[192:195], a[68:71], v[112:127]
    ds_read_b64_tr_b16 v[176:177], v24 offset:6208
    v_fmac_f32 v239, v34, v236
    ds_write_b64 v37, v[238:239] offset:2816
    ds_read_b64 v[208:209], v249 offset:1024
    ds_read_b64 v[210:211], v249 offset:1280
    ds_read_b64 v[212:213], v249 offset:1536
    ds_read_b64 v[214:215], v249 offset:1792
    v_mfma_f32_32x32x16_bf16 v[128:143], v[192:195], a[84:87], v[128:143]
    ds_read_b64_tr_b16 v[178:179], v24 offset:6976
    s_add_u32 s51, s34, 128
    s_add_u32 m0, s50, 32768
    s_nop 0
    buffer_load_dwordx4 v5, s[68:71], s51 offen offset:0 lds
    ds_read_b64 v[216:217], v249 offset:2048
    ds_read_b64 v[218:219], v249 offset:2304
    ds_read_b64 v[220:221], v249 offset:2560
    s_waitcnt lgkmcnt(15)
    v_mfma_f32_32x32x16_bf16 v[144:159], v[196:199], a[68:71], v[144:159]
    ds_read_b64_tr_b16 v[180:181], v24 offset:9216
    ds_read_b64 v[222:223], v249 offset:2816
    s_lshl_b32 s12, s4, 7
    v_add_u32 v240, s12, v3
    ds_read_b128 v[224:227], v240 offset:5120
    ds_read_b128 v[228:231], v240 offset:5152
    ds_read_b128 v[232:235], v240 offset:5184
    ds_read_b128 v[236:239], v240 offset:5216
    v_mfma_f32_32x32x16_bf16 v[160:175], v[196:199], a[84:87], v[160:175]
    ds_read_b64_tr_b16 v[182:183], v24 offset:9984
    buffer_load_dwordx4 v6, s[68:71], s51 offen offset:1024 lds
    s_waitcnt lgkmcnt(15)
    v_mfma_f32_32x32x16_bf16 v[80:95], v[200:203], a[72:75], v[80:95]
    ds_read_b64_tr_b16 v[184:185], v25 offset:9248
    v_mfma_f32_32x32x16_bf16 v[96:111], v[200:203], a[88:91], v[96:111]
    ds_read_b64_tr_b16 v[186:187], v25 offset:10016
    buffer_load_dwordx4 v7, s[68:71], s51 offen offset:2048 lds
    s_waitcnt lgkmcnt(15)
    v_mfma_f32_32x32x16_bf16 v[112:127], v[204:207], a[72:75], v[112:127]
    ds_read_b64_tr_b16 v[188:189], v24 offset:9280
    v_mfma_f32_32x32x16_bf16 v[128:143], v[204:207], a[88:91], v[128:143]
    ds_read_b64_tr_b16 v[190:191], v24 offset:10048
    buffer_load_dwordx4 v8, s[68:71], s51 offen offset:3072 lds
    s_waitcnt lgkmcnt(14)
    v_mfma_f32_32x32x16_bf16 v[144:159], v[176:179], a[72:75], v[144:159]
    s_barrier
    ds_read_b64_tr_b16 v[192:193], v24 offset:24576
    v_mfma_f32_32x32x16_bf16 v[160:175], v[176:179], a[88:91], v[160:175]
    ds_read_b64_tr_b16 v[194:195], v24 offset:25344
    s_add_u32 s11, s23, 5
    s_and_b32 s11, s11, 7
    s_mul_i32 s101, s11, s22
    s_add_u32 m0, s100, 98304
    s_nop 0
    buffer_load_dwordx4 v13, s[60:63], s101 offen offset:0 lds
    s_waitcnt lgkmcnt(6)
    v_mfma_f32_32x32x16_bf16 v[80:95], v[180:183], a[76:79], v[80:95]
    ds_read_b64_tr_b16 v[196:197], v25 offset:24608
    v_fmac_f32 v210, v29, v208
    v_fmac_f32 v211, v29, v209
    v_fmac_f32 v210, v10, v209
    v_fmac_f32 v211, v30, v208
    v_fmac_f32 v212, v29, v210
    v_fmac_f32 v213, v29, v211
    v_mfma_f32_32x32x16_bf16 v[96:111], v[180:183], a[92:95], v[96:111]
    ds_read_b64_tr_b16 v[198:199], v25 offset:25376
    buffer_load_dwordx4 v14, s[60:63], s101 offen offset:1024 lds
    v_fmac_f32 v212, v10, v211
    v_fmac_f32 v213, v30, v210
    v_fmac_f32 v214, v29, v212
    s_waitcnt lgkmcnt(6)
    v_mfma_f32_32x32x16_bf16 v[112:127], v[184:187], a[76:79], v[112:127]
    ds_read_b64_tr_b16 v[200:201], v24 offset:24640
    v_fmac_f32 v215, v29, v213
    v_fmac_f32 v214, v10, v213
    v_fmac_f32 v215, v30, v212
    v_fmac_f32 v216, v29, v214
    v_fmac_f32 v217, v29, v215
    v_fmac_f32 v216, v10, v215
    v_mfma_f32_32x32x16_bf16 v[128:143], v[184:187], a[92:95], v[128:143]
    ds_read_b64_tr_b16 v[202:203], v24 offset:25408
    buffer_load_dwordx4 v15, s[60:63], s101 offen offset:2048 lds
    v_fmac_f32 v217, v30, v214
    v_fmac_f32 v218, v29, v216
    v_fmac_f32 v219, v29, v217
    s_waitcnt lgkmcnt(6)
    v_mfma_f32_32x32x16_bf16 v[144:159], v[188:191], a[76:79], v[144:159]
    ds_read_b64_tr_b16 v[204:205], v24 offset:27648
    v_fmac_f32 v218, v10, v217
    v_fmac_f32 v219, v30, v216
    v_fmac_f32 v220, v29, v218
    v_fmac_f32 v221, v29, v219
    v_fmac_f32 v220, v10, v219
    v_fmac_f32 v221, v30, v218
    v_mfma_f32_32x32x16_bf16 v[160:175], v[188:191], a[92:95], v[160:175]
    ds_read_b64_tr_b16 v[206:207], v24 offset:28416
    s_add_u32 m0, s100, 110592
    v_xor_b32 v26, 32, v13
    buffer_load_dwordx4 v26, s[64:67], s101 offen offset:0 lds
    v_fmac_f32 v222, v29, v220
    v_fmac_f32 v223, v29, v221
    v_fmac_f32 v222, v10, v221
    s_waitcnt lgkmcnt(6)
    v_mfma_f32_32x32x16_bf16 v[80:95], v[192:195], a[96:99], v[80:95]
    ds_read_b64_tr_b16 v[176:177], v25 offset:27680
    v_fmac_f32 v223, v30, v220
    v_mul_f32 v210, v35, v222
    v_mul_f32 v211, v36, v222
    v_fmac_f32 v210, v36, v223
    v_fma_f32 v211, -v35, v223, v211
    v_mul_f32 v208, v27, v210
    v_mfma_f32_32x32x16_bf16 v[96:111], v[192:195], a[112:115], v[96:111]
    ds_read_b64_tr_b16 v[178:179], v25 offset:28448
    v_xor_b32 v26, 32, v14
    buffer_load_dwordx4 v26, s[64:67], s101 offen offset:1024 lds
    v_mul_f32 v209, v27, v211
    v_fmac_f32 v208, v28, v211
    v_fmac_f32 v209, v9, v210
    s_waitcnt lgkmcnt(6)
    v_mfma_f32_32x32x16_bf16 v[112:127], v[196:199], a[96:99], v[112:127]
    ds_read_b64_tr_b16 v[180:181], v24 offset:27712
    v_mul_f32 v210, v27, v208
    v_mul_f32 v211, v27, v209
    v_fmac_f32 v48, v224, v208
    v_fmac_f32 v64, v224, v209
    v_fmac_f32 v210, v28, v209
    v_fmac_f32 v211, v9, v208
    v_mfma_f32_32x32x16_bf16 v[128:143], v[196:199], a[112:115], v[128:143]
    ds_read_b64_tr_b16 v[182:183], v24 offset:28480
    v_xor_b32 v26, 32, v15
    buffer_load_dwordx4 v26, s[64:67], s101 offen offset:2048 lds
    v_mul_f32 v208, v27, v210
    v_mul_f32 v209, v27, v211
    v_fmac_f32 v49, v225, v210
    s_waitcnt lgkmcnt(6)
    v_mfma_f32_32x32x16_bf16 v[144:159], v[200:203], a[96:99], v[144:159]
    ds_read_b64_tr_b16 v[184:185], v24 offset:30720
    s_waitcnt vmcnt(10)
    ds_read_b128 a[16:19], v20 offset:16384
    ds_read_b128 a[20:23], v21 offset:16384
    ds_read_b128 a[24:27], v22 offset:16384
    ds_read_b128 a[28:31], v23 offset:16384
    v_fmac_f32 v65, v225, v211
    v_fmac_f32 v208, v28, v211
    v_fmac_f32 v209, v9, v210
    v_cvt_pk_bf16_f32 v48, v48, v49
    v_cvt_pk_bf16_f32 v64, v64, v65
    v_mul_f32 v210, v27, v208
    v_mfma_f32_32x32x16_bf16 v[160:175], v[200:203], a[112:115], v[160:175]
    ds_read_b64_tr_b16 v[186:187], v24 offset:31488
    s_add_u32 s51, s34, 32896
    s_add_u32 m0, s50, 0
    s_nop 0
    buffer_load_dwordx4 v5, s[68:71], s51 offen offset:0 lds
    v_mul_f32 v211, v27, v209
    v_fmac_f32 v50, v226, v208
    v_fmac_f32 v66, v226, v209
    s_waitcnt lgkmcnt(10)
    v_mfma_f32_32x32x16_bf16 v[80:95], v[204:207], a[100:103], v[80:95]
    ds_read_b64_tr_b16 v[188:189], v25 offset:30752
    v_fmac_f32 v210, v28, v209
    v_fmac_f32 v211, v9, v208
    v_mul_f32 v208, v27, v210
    v_mul_f32 v209, v27, v211
    v_fmac_f32 v51, v227, v210
    v_fmac_f32 v67, v227, v211
    v_mfma_f32_32x32x16_bf16 v[96:111], v[204:207], a[116:119], v[96:111]
    ds_read_b64_tr_b16 v[190:191], v25 offset:31520
    buffer_load_dwordx4 v6, s[68:71], s51 offen offset:1024 lds
    v_fmac_f32 v208, v28, v211
    v_fmac_f32 v209, v9, v210
    v_cvt_pk_bf16_f32 v49, v50, v51
    s_waitcnt lgkmcnt(10)
    v_mfma_f32_32x32x16_bf16 v[112:127], v[176:179], a[100:103], v[112:127]
    ds_read_b64_tr_b16 v[192:193], v24 offset:30784
    v_cvt_pk_bf16_f32 v65, v66, v67
    v_mul_f32 v210, v27, v208
    v_mul_f32 v211, v27, v209
    v_fmac_f32 v52, v228, v208
    v_fmac_f32 v68, v228, v209
    v_fmac_f32 v210, v28, v209
    v_mfma_f32_32x32x16_bf16 v[128:143], v[176:179], a[116:119], v[128:143]
    ds_read_b64_tr_b16 v[194:195], v24 offset:31552
    buffer_load_dwordx4 v7, s[68:71], s51 offen offset:2048 lds
    v_fmac_f32 v211, v9, v208
    v_mul_f32 v208, v27, v210
    v_mul_f32 v209, v27, v211
    s_waitcnt lgkmcnt(10)
    v_mfma_f32_32x32x16_bf16 v[144:159], v[180:183], a[100:103], v[144:159]
    ds_read_b64_tr_b16 v[196:197], v24 offset:33792
    v_fmac_f32 v53, v229, v210
    v_fmac_f32 v69, v229, v211
    v_fmac_f32 v208, v28, v211
    v_fmac_f32 v209, v9, v210
    v_cvt_pk_bf16_f32 v50, v52, v53
    v_cvt_pk_bf16_f32 v66, v68, v69
    v_mfma_f32_32x32x16_bf16 v[160:175], v[180:183], a[116:119], v[160:175]
    ds_read_b64_tr_b16 v[198:199], v24 offset:34560
    s_waitcnt vmcnt(9)
    ds_read_b128 a[32:35], v20 offset:32768
    ds_read_b128 a[36:39], v21 offset:32768
    ds_read_b128 a[40:43], v22 offset:32768
    ds_read_b128 a[44:47], v23 offset:32768
    buffer_load_dwordx4 v8, s[68:71], s51 offen offset:3072 lds
    v_mul_f32 v210, v27, v208
    v_mul_f32 v211, v27, v209
    v_fmac_f32 v54, v230, v208
    s_waitcnt lgkmcnt(10)
    v_mfma_f32_32x32x16_bf16 v[80:95], v[184:187], a[104:107], v[80:95]
    ds_read_b64_tr_b16 v[200:201], v25 offset:33824
    v_fmac_f32 v70, v230, v209
    v_fmac_f32 v210, v28, v209
    v_fmac_f32 v211, v9, v208
    v_mul_f32 v208, v27, v210
    v_mul_f32 v209, v27, v211
    v_fmac_f32 v55, v231, v210
    v_mfma_f32_32x32x16_bf16 v[96:111], v[184:187], a[120:123], v[96:111]
    ds_read_b64_tr_b16 v[202:203], v25 offset:34592
    s_add_u32 s51, s34, 0
    s_add_u32 m0, s50, 16384
    s_nop 0
    buffer_load_dwordx4 v5, s[72:75], s51 offen offset:0 lds
    v_fmac_f32 v71, v231, v211
    v_fmac_f32 v208, v28, v211
    v_fmac_f32 v209, v9, v210
    s_waitcnt lgkmcnt(10)
    v_mfma_f32_32x32x16_bf16 v[112:127], v[188:191], a[104:107], v[112:127]
    ds_read_b64_tr_b16 v[204:205], v24 offset:33856
    v_cvt_pk_bf16_f32 v51, v54, v55
    v_cvt_pk_bf16_f32 v67, v70, v71
    v_mul_f32 v210, v27, v208
    v_mul_f32 v211, v27, v209
    v_fmac_f32 v56, v232, v208
    v_fmac_f32 v72, v232, v209
    v_mfma_f32_32x32x16_bf16 v[128:143], v[188:191], a[120:123], v[128:143]
    ds_read_b64_tr_b16 v[206:207], v24 offset:34624
    buffer_load_dwordx4 v6, s[72:75], s51 offen offset:1024 lds
    v_fmac_f32 v210, v28, v209
    v_fmac_f32 v211, v9, v208
    v_mul_f32 v208, v27, v210
    s_waitcnt lgkmcnt(10)
    v_mfma_f32_32x32x16_bf16 v[144:159], v[192:195], a[104:107], v[144:159]
    s_barrier
    ds_read_b64_tr_b16 v[176:177], v24 offset:49152
    v_mul_f32 v209, v27, v211
    v_fmac_f32 v57, v233, v210
    v_fmac_f32 v73, v233, v211
    v_fmac_f32 v208, v28, v211
    v_fmac_f32 v209, v9, v210
    v_cvt_pk_bf16_f32 v52, v56, v57
    v_mfma_f32_32x32x16_bf16 v[160:175], v[192:195], a[120:123], v[160:175]
    ds_read_b64_tr_b16 v[178:179], v24 offset:49920
    s_add_u32 s11, s23, 6
    s_and_b32 s11, s11, 7
    s_mul_i32 s101, s11, s22
    s_add_u32 m0, s100, 24576
    s_nop 0
    buffer_load_dwordx4 v13, s[60:63], s101 offen offset:0 lds
    v_cvt_pk_bf16_f32 v68, v72, v73
    v_mul_f32 v210, v27, v208
    v_mul_f32 v211, v27, v209
    s_waitcnt lgkmcnt(10)
    v_mfma_f32_32x32x16_bf16 v[80:95], v[196:199], a[108:111], v[80:95]
    ds_read_b64_tr_b16 v[180:181], v25 offset:49184
    v_fmac_f32 v58, v234, v208
    v_fmac_f32 v74, v234, v209
    v_fmac_f32 v210, v28, v209
    v_fmac_f32 v211, v9, v208
    v_mul_f32 v208, v27, v210
    v_mul_f32 v209, v27, v211
    v_mfma_f32_32x32x16_bf16 v[96:111], v[196:199], a[124:127], v[96:111]
    ds_read_b64_tr_b16 v[182:183], v25 offset:49952
    buffer_load_dwordx4 v14, s[60:63], s101 offen offset:1024 lds
    v_fmac_f32 v59, v235, v210
    v_fmac_f32 v75, v235, v211
    v_fmac_f32 v208, v28, v211
    s_waitcnt lgkmcnt(6)
    v_mfma_f32_32x32x16_bf16 v[112:127], v[200:203], a[108:111], v[112:127]
    ds_read_b64_tr_b16 v[184:185], v24 offset:49216
    v_fmac_f32 v209, v9, v210
    v_cvt_pk_bf16_f32 v53, v58, v59
    v_cvt_pk_bf16_f32 v69, v74, v75
    v_mul_f32 v210, v27, v208
    v_mul_f32 v211, v27, v209
    v_fmac_f32 v60, v236, v208
    v_mfma_f32_32x32x16_bf16 v[128:143], v[200:203], a[124:127], v[128:143]
    ds_read_b64_tr_b16 v[186:187], v24 offset:49984
    buffer_load_dwordx4 v15, s[60:63], s101 offen offset:2048 lds
    v_fmac_f32 v76, v236, v209
    v_fmac_f32 v210, v28, v209
    v_fmac_f32 v211, v9, v208
    s_waitcnt lgkmcnt(6)
    v_mfma_f32_32x32x16_bf16 v[144:159], v[204:207], a[108:111], v[144:159]
    ds_read_b64_tr_b16 v[188:189], v24 offset:52224
    v_mul_f32 v208, v27, v210
    v_mul_f32 v209, v27, v211
    v_fmac_f32 v61, v237, v210
    v_fmac_f32 v77, v237, v211
    v_fmac_f32 v208, v28, v211
    v_fmac_f32 v209, v9, v210
    v_mfma_f32_32x32x16_bf16 v[160:175], v[204:207], a[124:127], v[160:175]
    ds_read_b64_tr_b16 v[190:191], v24 offset:52992
    s_add_u32 m0, s100, 36864
    v_xor_b32 v26, 32, v13
    buffer_load_dwordx4 v26, s[64:67], s101 offen offset:0 lds
    v_cvt_pk_bf16_f32 v54, v60, v61
    v_cvt_pk_bf16_f32 v70, v76, v77
    v_mul_f32 v210, v27, v208
    s_waitcnt lgkmcnt(6)
    v_mfma_f32_32x32x16_bf16 v[80:95], v[176:179], a[128:131], v[80:95]
    ds_read_b64_tr_b16 v[192:193], v25 offset:52256
    v_mul_f32 v211, v27, v209
    v_fmac_f32 v62, v238, v208
    v_fmac_f32 v78, v238, v209
    v_fmac_f32 v210, v28, v209
    v_fmac_f32 v211, v9, v208
    v_fmac_f32 v63, v239, v210
    v_mfma_f32_32x32x16_bf16 v[96:111], v[176:179], a[144:147], v[96:111]
    ds_read_b64_tr_b16 v[194:195], v25 offset:53024
    v_xor_b32 v26, 32, v14
    buffer_load_dwordx4 v26, s[64:67], s101 offen offset:1024 lds
    v_fmac_f32 v79, v239, v211
    v_cvt_pk_bf16_f32 v55, v62, v63
    v_cvt_pk_bf16_f32 v71, v78, v79
    s_waitcnt lgkmcnt(6)
    v_mfma_f32_32x32x16_bf16 v[112:127], v[180:183], a[128:131], v[112:127]
    ds_read_b64_tr_b16 v[196:197], v24 offset:52288
    v_xor_b32 v240, 16, v246
    v_xor_b32 v241, 32, v247
    ds_write_b128 v246, v[48:51] offset:32768
    v_mfma_f32_32x32x16_bf16 v[128:143], v[180:183], a[144:147], v[128:143]
    ds_read_b64_tr_b16 v[198:199], v24 offset:53056
    v_xor_b32 v26, 32, v15
    buffer_load_dwordx4 v26, s[64:67], s101 offen offset:2048 lds
    ds_write_b128 v240, v[52:55] offset:32768
    s_waitcnt lgkmcnt(8)
    v_mfma_f32_32x32x16_bf16 v[144:159], v[184:187], a[128:131], v[144:159]
    ds_read_b64_tr_b16 v[200:201], v24 offset:55296
    ds_write_b128 v246, v[64:67] offset:34816
    v_mfma_f32_32x32x16_bf16 v[160:175], v[184:187], a[144:147], v[160:175]
    ds_read_b64_tr_b16 v[202:203], v24 offset:56064
    s_add_u32 m0, s50, 16384
    s_nop 0
    buffer_load_dwordx4 v7, s[72:75], s51 offen offset:2048 lds
    ds_write_b128 v240, v[68:71] offset:34816
    s_waitcnt lgkmcnt(10)
    v_mfma_f32_32x32x16_bf16 v[80:95], v[188:191], a[132:135], v[80:95]
    ds_read_b64_tr_b16 v[204:205], v25 offset:55328
    ds_read_b64_tr_b16 v[208:209], v247 offset:32768
    ds_read_b64_tr_b16 v[210:211], v241 offset:33024
    ds_read_b64_tr_b16 v[212:213], v247 offset:33792
    ds_read_b64_tr_b16 v[214:215], v241 offset:34048
    ds_read_b64_tr_b16 v[216:217], v247 offset:34816
    ds_read_b64_tr_b16 v[218:219], v241 offset:35072
    v_mfma_f32_32x32x16_bf16 v[96:111], v[188:191], a[148:151], v[96:111]
    ds_read_b64_tr_b16 v[206:207], v25 offset:56096
    s_waitcnt vmcnt(9)
    ds_read_b128 a[48:51], v20 offset:0
    ds_read_b128 a[52:55], v21 offset:0
    ds_read_b128 a[56:59], v22 offset:0
    ds_read_b128 a[60:63], v23 offset:0
    buffer_load_dwordx4 v8, s[72:75], s51 offen offset:3072 lds
    ds_read_b64_tr_b16 v[220:221], v247 offset:35840
    ds_read_b64_tr_b16 v[222:223], v241 offset:36096
    s_waitcnt lgkmcnt(15)
    v_mfma_f32_32x32x16_bf16 v[112:127], v[192:195], a[132:135], v[112:127]
    ds_read_b64_tr_b16 v[176:177], v24 offset:55360
    v_mfma_f32_32x32x16_bf16 v[128:143], v[192:195], a[148:151], v[128:143]
    ds_read_b64_tr_b16 v[178:179], v24 offset:56128
    s_waitcnt lgkmcnt(15)
    v_mfma_f32_32x32x16_bf16 v[144:159], v[196:199], a[132:135], v[144:159]
    ds_read_b64_tr_b16 v[180:181], v24 offset:58368
    v_mfma_f32_32x32x16_bf16 v[160:175], v[196:199], a[148:151], v[160:175]
    ds_read_b64_tr_b16 v[182:183], v24 offset:59136
    s_waitcnt lgkmcnt(15)
    v_mfma_f32_32x32x16_bf16 v[80:95], v[200:203], a[136:139], v[80:95]
    ds_read_b64_tr_b16 v[184:185], v25 offset:58400
    v_mfma_f32_32x32x16_bf16 v[96:111], v[200:203], a[152:155], v[96:111]
    ds_read_b64_tr_b16 v[186:187], v25 offset:59168
    s_waitcnt lgkmcnt(12)
    v_mfma_f32_32x32x16_bf16 v[112:127], v[204:207], a[136:139], v[112:127]
    ds_read_b64_tr_b16 v[188:189], v24 offset:58432
    v_mfma_f32_32x32x16_bf16 v[128:143], v[204:207], a[152:155], v[128:143]
    ds_read_b64_tr_b16 v[190:191], v24 offset:59200
    s_waitcnt lgkmcnt(6)
    v_mfma_f32_32x32x16_bf16 v[144:159], v[176:179], a[136:139], v[144:159]
    s_barrier
    v_add_u32 v24, 0x12000, v24
    v_add_u32 v25, 0x12000, v25
    ds_read_b64_tr_b16 v[192:193], v24 offset:0
    buffer_store_dwordx4 v[208:211], v4, s[80:83], s40 offen offset:0 sc1
    v_mfma_f32_32x32x16_bf16 v[160:175], v[176:179], a[152:155], v[160:175]
    ds_read_b64_tr_b16 v[194:195], v24 offset:768
    s_add_u32 s11, s23, 7
    s_and_b32 s11, s11, 7
    s_mul_i32 s101, s11, s22
    s_add_u32 m0, s100, 49152
    s_nop 0
    buffer_load_dwordx4 v13, s[60:63], s101 offen offset:0 lds
    s_waitcnt lgkmcnt(6)
    v_mfma_f32_32x32x16_bf16 v[80:95], v[180:183], a[140:143], v[80:95]
    ds_read_b64_tr_b16 v[196:197], v25 offset:32
    buffer_store_dwordx4 v[212:215], v4, s[80:83], s40 offen offset:1024 sc1
    v_mfma_f32_32x32x16_bf16 v[96:111], v[180:183], a[156:159], v[96:111]
    ds_read_b64_tr_b16 v[198:199], v25 offset:800
    buffer_load_dwordx4 v14, s[60:63], s101 offen offset:1024 lds
    s_waitcnt lgkmcnt(6)
    v_mfma_f32_32x32x16_bf16 v[112:127], v[184:187], a[140:143], v[112:127]
    ds_read_b64_tr_b16 v[200:201], v24 offset:64
    buffer_store_dwordx4 v[216:219], v4, s[80:83], s40 offen offset:2048 sc1
    v_mfma_f32_32x32x16_bf16 v[128:143], v[184:187], a[156:159], v[128:143]
    ds_read_b64_tr_b16 v[202:203], v24 offset:832
    buffer_load_dwordx4 v15, s[60:63], s101 offen offset:2048 lds
    s_waitcnt lgkmcnt(6)
    v_mfma_f32_32x32x16_bf16 v[144:159], v[188:191], a[140:143], v[144:159]
    ds_read_b64_tr_b16 v[204:205], v24 offset:3072
    buffer_store_dwordx4 v[220:223], v4, s[80:83], s40 offen offset:3072 sc1
    v_mfma_f32_32x32x16_bf16 v[160:175], v[188:191], a[156:159], v[160:175]
    ds_read_b64_tr_b16 v[206:207], v24 offset:3840
    s_add_u32 m0, s100, 61440
    v_xor_b32 v26, 32, v13
    buffer_load_dwordx4 v26, s[64:67], s101 offen offset:0 lds
    s_waitcnt lgkmcnt(6)
    v_mfma_f32_32x32x16_bf16 v[80:95], v[192:195], a[160:163], v[80:95]
    ds_read_b64_tr_b16 v[176:177], v25 offset:3104
    v_mfma_f32_32x32x16_bf16 v[96:111], v[192:195], a[176:179], v[96:111]
    ds_read_b64_tr_b16 v[178:179], v25 offset:3872
    v_xor_b32 v26, 32, v14
    buffer_load_dwordx4 v26, s[64:67], s101 offen offset:1024 lds
    s_waitcnt lgkmcnt(6)
    v_mfma_f32_32x32x16_bf16 v[112:127], v[196:199], a[160:163], v[112:127]
    ds_read_b64_tr_b16 v[180:181], v24 offset:3136
    v_mfma_f32_32x32x16_bf16 v[128:143], v[196:199], a[176:179], v[128:143]
    ds_read_b64_tr_b16 v[182:183], v24 offset:3904
    v_xor_b32 v26, 32, v15
    buffer_load_dwordx4 v26, s[64:67], s101 offen offset:2048 lds
    s_waitcnt lgkmcnt(6)
    v_mfma_f32_32x32x16_bf16 v[144:159], v[200:203], a[160:163], v[144:159]
    ds_read_b64_tr_b16 v[184:185], v24 offset:6144
    s_waitcnt vmcnt(10)
    ds_read_b128 a[64:67], v20 offset:16384
    ds_read_b128 a[68:71], v21 offset:16384
    ds_read_b128 a[72:75], v22 offset:16384
    ds_read_b128 a[76:79], v23 offset:16384
    v_mfma_f32_32x32x16_bf16 v[160:175], v[200:203], a[176:179], v[160:175]
    ds_read_b64_tr_b16 v[186:187], v24 offset:6912
    s_waitcnt lgkmcnt(10)
    v_mfma_f32_32x32x16_bf16 v[80:95], v[204:207], a[164:167], v[80:95]
    ds_read_b64_tr_b16 v[188:189], v25 offset:6176
    v_mfma_f32_32x32x16_bf16 v[96:111], v[204:207], a[180:183], v[96:111]
    ds_read_b64_tr_b16 v[190:191], v25 offset:6944
    s_waitcnt lgkmcnt(10)
    v_mfma_f32_32x32x16_bf16 v[112:127], v[176:179], a[164:167], v[112:127]
    ds_read_b64_tr_b16 v[192:193], v24 offset:6208
    v_mfma_f32_32x32x16_bf16 v[128:143], v[176:179], a[180:183], v[128:143]
    ds_read_b64_tr_b16 v[194:195], v24 offset:6976
    s_add_u32 s51, s34, 32768
    s_add_u32 m0, s50, 0
    s_nop 0
    buffer_load_dwordx4 v5, s[72:75], s51 offen offset:0 lds
    s_waitcnt lgkmcnt(10)
    v_mfma_f32_32x32x16_bf16 v[144:159], v[180:183], a[164:167], v[144:159]
    ds_read_b64_tr_b16 v[196:197], v24 offset:9216
    v_mfma_f32_32x32x16_bf16 v[160:175], v[180:183], a[180:183], v[160:175]
    ds_read_b64_tr_b16 v[198:199], v24 offset:9984
    buffer_load_dwordx4 v6, s[72:75], s51 offen offset:1024 lds
    s_waitcnt lgkmcnt(6)
    v_mfma_f32_32x32x16_bf16 v[80:95], v[184:187], a[168:171], v[80:95]
    ds_read_b64_tr_b16 v[200:201], v25 offset:9248
    v_mfma_f32_32x32x16_bf16 v[96:111], v[184:187], a[184:187], v[96:111]
    ds_read_b64_tr_b16 v[202:203], v25 offset:10016
    buffer_load_dwordx4 v7, s[72:75], s51 offen offset:2048 lds
    s_waitcnt lgkmcnt(6)
    v_mfma_f32_32x32x16_bf16 v[112:127], v[188:191], a[168:171], v[112:127]
    ds_read_b64_tr_b16 v[204:205], v24 offset:9280
    v_mfma_f32_32x32x16_bf16 v[128:143], v[188:191], a[184:187], v[128:143]
    ds_read_b64_tr_b16 v[206:207], v24 offset:10048
    buffer_load_dwordx4 v8, s[72:75], s51 offen offset:3072 lds
    s_waitcnt lgkmcnt(6)
    v_mfma_f32_32x32x16_bf16 v[144:159], v[192:195], a[168:171], v[144:159]
    s_barrier
    v_add_u32 v24, 0xfffee000, v24
    v_add_u32 v25, 0xfffee000, v25
    ds_read_b64_tr_b16 v[176:177], v24 offset:0
    v_mfma_f32_32x32x16_bf16 v[160:175], v[192:195], a[184:187], v[160:175]
    ds_read_b64_tr_b16 v[178:179], v24 offset:768
    s_add_u32 s51, s34, 128
    s_add_u32 m0, s50, 32768
    s_nop 0
    buffer_load_dwordx4 v5, s[72:75], s51 offen offset:0 lds
    s_waitcnt lgkmcnt(6)
    v_mfma_f32_32x32x16_bf16 v[80:95], v[196:199], a[172:175], v[80:95]
    ds_read_b64_tr_b16 v[180:181], v25 offset:32
    v_mfma_f32_32x32x16_bf16 v[96:111], v[196:199], a[188:191], v[96:111]
    ds_read_b64_tr_b16 v[182:183], v25 offset:800
    buffer_load_dwordx4 v6, s[72:75], s51 offen offset:1024 lds
    s_waitcnt lgkmcnt(6)
    v_mfma_f32_32x32x16_bf16 v[112:127], v[200:203], a[172:175], v[112:127]
    ds_read_b64_tr_b16 v[184:185], v24 offset:64
    v_mfma_f32_32x32x16_bf16 v[128:143], v[200:203], a[188:191], v[128:143]
    ds_read_b64_tr_b16 v[186:187], v24 offset:832
    buffer_load_dwordx4 v7, s[72:75], s51 offen offset:2048 lds
    s_waitcnt lgkmcnt(6)
    v_mfma_f32_32x32x16_bf16 v[144:159], v[204:207], a[172:175], v[144:159]
    ds_read_b64_tr_b16 v[188:189], v24 offset:3072
    s_waitcnt vmcnt(10)
    buffer_store_dword v245, v244, s[80:83], 0 offen sc1
    v_mfma_f32_32x32x16_bf16 v[160:175], v[204:207], a[188:191], v[160:175]
    ds_read_b64_tr_b16 v[190:191], v24 offset:3840
    buffer_load_dwordx4 v8, s[72:75], s51 offen offset:3072 lds
    s_waitcnt lgkmcnt(6)
    v_mfma_f32_32x32x16_bf16 v[80:95], v[176:179], a[192:195], v[80:95]
    ds_read_b64_tr_b16 v[192:193], v25 offset:3104
    v_mfma_f32_32x32x16_bf16 v[96:111], v[176:179], a[208:211], v[96:111]
    ds_read_b64_tr_b16 v[194:195], v25 offset:3872
    s_add_u32 s51, s34, 32896
    s_add_u32 m0, s50, 16384
    s_nop 0
    buffer_load_dwordx4 v5, s[72:75], s51 offen offset:0 lds
    s_waitcnt lgkmcnt(6)
    v_mfma_f32_32x32x16_bf16 v[112:127], v[180:183], a[192:195], v[112:127]
    ds_read_b64_tr_b16 v[196:197], v24 offset:3136
    v_mfma_f32_32x32x16_bf16 v[128:143], v[180:183], a[208:211], v[128:143]
    ds_read_b64_tr_b16 v[198:199], v24 offset:3904
    buffer_load_dwordx4 v6, s[72:75], s51 offen offset:1024 lds
    s_waitcnt lgkmcnt(6)
    v_mfma_f32_32x32x16_bf16 v[144:159], v[184:187], a[192:195], v[144:159]
    ds_read_b64_tr_b16 v[200:201], v24 offset:6144
    v_mfma_f32_32x32x16_bf16 v[160:175], v[184:187], a[208:211], v[160:175]
    ds_read_b64_tr_b16 v[202:203], v24 offset:6912
    buffer_load_dwordx4 v7, s[72:75], s51 offen offset:2048 lds
    s_waitcnt lgkmcnt(6)
    v_mfma_f32_32x32x16_bf16 v[80:95], v[188:191], a[196:199], v[80:95]
    ds_read_b64_tr_b16 v[204:205], v25 offset:6176
    v_mfma_f32_32x32x16_bf16 v[96:111], v[188:191], a[212:215], v[96:111]
    ds_read_b64_tr_b16 v[206:207], v25 offset:6944
    buffer_load_dwordx4 v8, s[72:75], s51 offen offset:3072 lds
    s_waitcnt lgkmcnt(6)
    v_mfma_f32_32x32x16_bf16 v[112:127], v[192:195], a[196:199], v[112:127]
    ds_read_b64_tr_b16 v[176:177], v24 offset:6208
    v_mfma_f32_32x32x16_bf16 v[128:143], v[192:195], a[212:215], v[128:143]
    ds_read_b64_tr_b16 v[178:179], v24 offset:6976
    s_add_u32 s51, s35, 0
    s_add_u32 m0, s50, 114688
    s_nop 0
    buffer_load_dwordx4 v42, s[76:79], s51 offen offset:0 lds
    s_waitcnt lgkmcnt(6)
    v_mfma_f32_32x32x16_bf16 v[144:159], v[196:199], a[196:199], v[144:159]
    ds_read_b64_tr_b16 v[180:181], v24 offset:9216
    v_mfma_f32_32x32x16_bf16 v[160:175], v[196:199], a[212:215], v[160:175]
    ds_read_b64_tr_b16 v[182:183], v24 offset:9984
    s_waitcnt vmcnt(10)
    ds_read_b128 a[80:83], v20 offset:0
    ds_read_b128 a[84:87], v21 offset:0
    ds_read_b128 a[88:91], v22 offset:0
    ds_read_b128 a[92:95], v23 offset:0
    buffer_load_dwordx4 v43, s[76:79], s51 offen offset:1024 lds
    s_waitcnt lgkmcnt(10)
    v_mfma_f32_32x32x16_bf16 v[80:95], v[200:203], a[200:203], v[80:95]
    ds_read_b64_tr_b16 v[184:185], v25 offset:9248
    v_mfma_f32_32x32x16_bf16 v[96:111], v[200:203], a[216:219], v[96:111]
    ds_read_b64_tr_b16 v[186:187], v25 offset:10016
    buffer_load_dwordx4 v44, s[76:79], s51 offen offset:2048 lds
    s_waitcnt lgkmcnt(10)
    v_mfma_f32_32x32x16_bf16 v[112:127], v[204:207], a[200:203], v[112:127]
    ds_read_b64_tr_b16 v[188:189], v24 offset:9280
    v_mfma_f32_32x32x16_bf16 v[128:143], v[204:207], a[216:219], v[128:143]
    ds_read_b64_tr_b16 v[190:191], v24 offset:10048
    buffer_load_dwordx4 v45, s[76:79], s51 offen offset:3072 lds
    s_waitcnt lgkmcnt(10)
    v_mfma_f32_32x32x16_bf16 v[144:159], v[176:179], a[200:203], v[144:159]
    s_barrier
    ds_read_b64_tr_b16 v[192:193], v24 offset:24576
    s_add_u32 s51, s35, 32768
    s_add_u32 m0, s50, 131072
    s_nop 0
    buffer_load_dwordx4 v42, s[76:79], s51 offen offset:0 lds
    v_mfma_f32_32x32x16_bf16 v[160:175], v[176:179], a[216:219], v[160:175]
    ds_read_b64_tr_b16 v[194:195], v24 offset:25344
    buffer_load_dwordx4 v43, s[76:79], s51 offen offset:1024 lds
    s_waitcnt lgkmcnt(10)
    v_mfma_f32_32x32x16_bf16 v[80:95], v[180:183], a[204:207], v[80:95]
    ds_read_b64_tr_b16 v[196:197], v25 offset:24608
    v_mfma_f32_32x32x16_bf16 v[96:111], v[180:183], a[220:223], v[96:111]
    ds_read_b64_tr_b16 v[198:199], v25 offset:25376
    s_waitcnt vmcnt(10)
    ds_read_b128 a[96:99], v20 offset:32768
    ds_read_b128 a[100:103], v21 offset:32768
    ds_read_b128 a[104:107], v22 offset:32768
    ds_read_b128 a[108:111], v23 offset:32768
    buffer_load_dwordx4 v44, s[76:79], s51 offen offset:2048 lds
    s_waitcnt lgkmcnt(10)
    v_mfma_f32_32x32x16_bf16 v[112:127], v[184:187], a[204:207], v[112:127]
    ds_read_b64_tr_b16 v[200:201], v24 offset:24640
    buffer_load_dwordx4 v45, s[76:79], s51 offen offset:3072 lds
    v_mfma_f32_32x32x16_bf16 v[128:143], v[184:187], a[220:223], v[128:143]
    ds_read_b64_tr_b16 v[202:203], v24 offset:25408
    s_waitcnt lgkmcnt(10)
    v_mfma_f32_32x32x16_bf16 v[144:159], v[188:191], a[204:207], v[144:159]
    ds_read_b64_tr_b16 v[204:205], v24 offset:27648
    s_add_u32 s51, s35, 65536
    s_add_u32 m0, s50, 0
    s_nop 0
    buffer_load_dwordx4 v42, s[76:79], s51 offen offset:0 lds
    v_mfma_f32_32x32x16_bf16 v[160:175], v[188:191], a[220:223], v[160:175]
    ds_read_b64_tr_b16 v[206:207], v24 offset:28416
    buffer_load_dwordx4 v43, s[76:79], s51 offen offset:1024 lds
    s_waitcnt lgkmcnt(10)
    v_mfma_f32_32x32x16_bf16 v[80:95], v[192:195], a[224:227], v[80:95]
    ds_read_b64_tr_b16 v[176:177], v25 offset:27680
    v_mfma_f32_32x32x16_bf16 v[96:111], v[192:195], a[240:243], v[96:111]
    ds_read_b64_tr_b16 v[178:179], v25 offset:28448
    s_barrier
    buffer_load_dwordx4 v44, s[76:79], s51 offen offset:2048 lds
    s_waitcnt lgkmcnt(10)
    v_mfma_f32_32x32x16_bf16 v[112:127], v[196:199], a[224:227], v[112:127]
    ds_read_b64_tr_b16 v[180:181], v24 offset:27712
    buffer_load_dwordx4 v45, s[76:79], s51 offen offset:3072 lds
    v_mfma_f32_32x32x16_bf16 v[128:143], v[196:199], a[240:243], v[128:143]
    ds_read_b64_tr_b16 v[182:183], v24 offset:28480
    s_waitcnt vmcnt(12)
    ds_read_b128 a[112:115], v20 offset:16384
    ds_read_b128 a[116:119], v21 offset:16384
    ds_read_b128 a[120:123], v22 offset:16384
    ds_read_b128 a[124:127], v23 offset:16384
    s_waitcnt lgkmcnt(10)
    v_mfma_f32_32x32x16_bf16 v[144:159], v[200:203], a[224:227], v[144:159]
    ds_read_b64_tr_b16 v[184:185], v24 offset:30720
    s_add_u32 s51, s35, 98304
    s_add_u32 m0, s50, 49152
    s_nop 0
    buffer_load_dwordx4 v42, s[76:79], s51 offen offset:0 lds
    v_mfma_f32_32x32x16_bf16 v[160:175], v[200:203], a[240:243], v[160:175]
    ds_read_b64_tr_b16 v[186:187], v24 offset:31488
    buffer_load_dwordx4 v43, s[76:79], s51 offen offset:1024 lds
    s_waitcnt lgkmcnt(10)
    v_mfma_f32_32x32x16_bf16 v[80:95], v[204:207], a[228:231], v[80:95]
    ds_read_b64_tr_b16 v[188:189], v25 offset:30752
    v_mfma_f32_32x32x16_bf16 v[96:111], v[204:207], a[244:247], v[96:111]
    ds_read_b64_tr_b16 v[190:191], v25 offset:31520
    buffer_load_dwordx4 v44, s[76:79], s51 offen offset:2048 lds
    s_waitcnt lgkmcnt(10)
    v_mfma_f32_32x32x16_bf16 v[112:127], v[176:179], a[228:231], v[112:127]
    ds_read_b64_tr_b16 v[192:193], v24 offset:30784
    buffer_load_dwordx4 v45, s[76:79], s51 offen offset:3072 lds
    v_mfma_f32_32x32x16_bf16 v[128:143], v[176:179], a[244:247], v[128:143]
    ds_read_b64_tr_b16 v[194:195], v24 offset:31552
    s_waitcnt lgkmcnt(10)
    v_mfma_f32_32x32x16_bf16 v[144:159], v[180:183], a[228:231], v[144:159]
    ds_read_b64_tr_b16 v[196:197], v24 offset:33792
    s_add_u32 s51, s35, 131072
    s_add_u32 m0, s50, 65536
    s_nop 0
    buffer_load_dwordx4 v42, s[76:79], s51 offen offset:0 lds
    v_mfma_f32_32x32x16_bf16 v[160:175], v[180:183], a[244:247], v[160:175]
    ds_read_b64_tr_b16 v[198:199], v24 offset:34560
    s_waitcnt vmcnt(13)
    v_add_u32 v252, 114688, v16
    ds_read_b64_tr_b16 a[128:129], v252 offset:0
    ds_read_b64_tr_b16 a[130:131], v252 offset:1024
    ds_read_b64_tr_b16 a[136:137], v252 offset:2048
    ds_read_b64_tr_b16 a[138:139], v252 offset:3072
    v_add_u32 v253, 114688, v17
    ds_read_b64_tr_b16 a[132:133], v253 offset:0
    ds_read_b64_tr_b16 a[134:135], v253 offset:1024
    ds_read_b64_tr_b16 a[140:141], v253 offset:2048
    ds_read_b64_tr_b16 a[142:143], v253 offset:3072
    buffer_load_dwordx4 v43, s[76:79], s51 offen offset:1024 lds
    s_waitcnt lgkmcnt(14)
    v_mfma_f32_32x32x16_bf16 v[80:95], v[184:187], a[232:235], v[80:95]
    ds_read_b64_tr_b16 v[200:201], v25 offset:33824
    v_mfma_f32_32x32x16_bf16 v[96:111], v[184:187], a[248:251], v[96:111]
    ds_read_b64_tr_b16 v[202:203], v25 offset:34592
    buffer_load_dwordx4 v44, s[76:79], s51 offen offset:2048 lds
    s_waitcnt lgkmcnt(14)
    v_mfma_f32_32x32x16_bf16 v[112:127], v[188:191], a[232:235], v[112:127]
    ds_read_b64_tr_b16 v[204:205], v24 offset:33856
    buffer_load_dwordx4 v45, s[76:79], s51 offen offset:3072 lds
    v_mfma_f32_32x32x16_bf16 v[128:143], v[188:191], a[248:251], v[128:143]
    ds_read_b64_tr_b16 v[206:207], v24 offset:34624
    s_waitcnt lgkmcnt(14)
    v_mfma_f32_32x32x16_bf16 v[144:159], v[192:195], a[232:235], v[144:159]
    s_waitcnt vmcnt(12)
    v_add_u32 v252, 131072, v16
    ds_read_b64_tr_b16 a[144:145], v252 offset:0
    ds_read_b64_tr_b16 a[146:147], v252 offset:1024
    ds_read_b64_tr_b16 a[152:153], v252 offset:2048
    ds_read_b64_tr_b16 a[154:155], v252 offset:3072
    v_add_u32 v253, 131072, v17
    ds_read_b64_tr_b16 a[148:149], v253 offset:0
    ds_read_b64_tr_b16 a[150:151], v253 offset:1024
    ds_read_b64_tr_b16 a[156:157], v253 offset:2048
    ds_read_b64_tr_b16 a[158:159], v253 offset:3072
    s_add_u32 s51, s35, 163840
    s_add_u32 m0, s50, 32768
    s_nop 0
    buffer_load_dwordx4 v42, s[76:79], s51 offen offset:0 lds
    v_mfma_f32_32x32x16_bf16 v[160:175], v[192:195], a[248:251], v[160:175]
    buffer_load_dwordx4 v43, s[76:79], s51 offen offset:1024 lds
    s_waitcnt lgkmcnt(15)
    v_mfma_f32_32x32x16_bf16 v[80:95], v[196:199], a[236:239], v[80:95]
    v_mfma_f32_32x32x16_bf16 v[96:111], v[196:199], a[252:255], v[96:111]
    buffer_load_dwordx4 v44, s[76:79], s51 offen offset:2048 lds
    s_waitcnt lgkmcnt(10)
    v_mfma_f32_32x32x16_bf16 v[112:127], v[200:203], a[236:239], v[112:127]
    buffer_load_dwordx4 v45, s[76:79], s51 offen offset:3072 lds
    v_mfma_f32_32x32x16_bf16 v[128:143], v[200:203], a[252:255], v[128:143]
    s_waitcnt lgkmcnt(8)
    v_mfma_f32_32x32x16_bf16 v[144:159], v[204:207], a[236:239], v[144:159]
    s_waitcnt vmcnt(12)
    ds_read_b64_tr_b16 a[160:161], v16 offset:0
    ds_read_b64_tr_b16 a[162:163], v16 offset:1024
    ds_read_b64_tr_b16 a[168:169], v16 offset:2048
    ds_read_b64_tr_b16 a[170:171], v16 offset:3072
    ds_read_b64_tr_b16 a[164:165], v17 offset:0
    ds_read_b64_tr_b16 a[166:167], v17 offset:1024
    ds_read_b64_tr_b16 a[172:173], v17 offset:2048
    ds_read_b64_tr_b16 a[174:175], v17 offset:3072
    s_add_u32 s51, s35, 196608
    s_add_u32 m0, s50, 16384
    s_nop 0
    buffer_load_dwordx4 v42, s[76:79], s51 offen offset:0 lds
    v_mfma_f32_32x32x16_bf16 v[160:175], v[204:207], a[252:255], v[160:175]
    buffer_load_dwordx4 v43, s[76:79], s51 offen offset:1024 lds
    s_waitcnt lgkmcnt(0)
    s_barrier
    s_cmp_eq_u32 s6, 15
    s_cselect_b32 s12, 0x80000000, 0
    v_or_b32 v224, s12, v4
    v_pk_mul_f32 v[176:177], v[80:81], s[24:25] op_sel_hi:[1,0]
    v_pk_mul_f32 v[178:179], v[82:83], s[24:25] op_sel_hi:[1,0]
    v_pk_mul_f32 v[180:181], v[84:85], s[24:25] op_sel_hi:[1,0]
    v_pk_mul_f32 v[182:183], v[86:87], s[24:25] op_sel_hi:[1,0]
    v_exp_f32 v176, v176
    v_exp_f32 v177, v177
    v_exp_f32 v178, v178
    v_exp_f32 v179, v179
    v_exp_f32 v180, v180
    v_exp_f32 v181, v181
    v_exp_f32 v182, v182
    v_exp_f32 v183, v183
    v_pk_mul_f32 v[80:81], v[80:81], v[88:89]
    v_pk_mul_f32 v[82:83], v[82:83], v[90:91]
    v_pk_mul_f32 v[84:85], v[84:85], v[92:93]
    v_pk_mul_f32 v[86:87], v[86:87], v[94:95]
    v_pk_fma_f32 v[176:177], v[176:177], v[40:41], v[40:41] op_sel_hi:[1,0,0]
    v_pk_fma_f32 v[178:179], v[178:179], v[40:41], v[40:41] op_sel_hi:[1,0,0]
    v_pk_fma_f32 v[180:181], v[180:181], v[40:41], v[40:41] op_sel_hi:[1,0,0]
    v_pk_fma_f32 v[182:183], v[182:183], v[40:41], v[40:41] op_sel_hi:[1,0,0]
    v_rcp_f32 v176, v176
    v_rcp_f32 v177, v177
    v_rcp_f32 v178, v178
    v_rcp_f32 v179, v179
    v_rcp_f32 v180, v180
    v_rcp_f32 v181, v181
    v_rcp_f32 v182, v182
    v_rcp_f32 v183, v183
    v_pk_mul_f32 v[80:81], v[80:81], v[176:177]
    v_pk_mul_f32 v[82:83], v[82:83], v[178:179]
    v_pk_mul_f32 v[84:85], v[84:85], v[180:181]
    v_pk_mul_f32 v[86:87], v[86:87], v[182:183]
    v_cvt_pk_bf16_f32 v184, v80, v81
    v_cvt_pk_bf16_f32 v185, v82, v83
    v_cvt_pk_bf16_f32 v186, v84, v85
    v_cvt_pk_bf16_f32 v187, v86, v87
    buffer_load_dword v242, v38, s[80:83], 0 offen sc1
    buffer_store_dwordx4 v[184:187], v224, s[80:83], s16 offen offset:0 sc1
    v_pk_mul_f32 v[176:177], v[96:97], s[24:25] op_sel_hi:[1,0]
    v_pk_mul_f32 v[178:179], v[98:99], s[24:25] op_sel_hi:[1,0]
    v_pk_mul_f32 v[180:181], v[100:101], s[24:25] op_sel_hi:[1,0]
    v_pk_mul_f32 v[182:183], v[102:103], s[24:25] op_sel_hi:[1,0]
    v_exp_f32 v176, v176
    v_exp_f32 v177, v177
    v_exp_f32 v178, v178
    v_exp_f32 v179, v179
    v_exp_f32 v180, v180
    v_exp_f32 v181, v181
    v_exp_f32 v182, v182
    v_exp_f32 v183, v183
    v_pk_mul_f32 v[96:97], v[96:97], v[104:105]
    v_pk_mul_f32 v[98:99], v[98:99], v[106:107]
    v_pk_mul_f32 v[100:101], v[100:101], v[108:109]
    v_pk_mul_f32 v[102:103], v[102:103], v[110:111]
    v_pk_fma_f32 v[176:177], v[176:177], v[40:41], v[40:41] op_sel:[0,1,1] op_sel_hi:[1,1,1]
    v_pk_fma_f32 v[178:179], v[178:179], v[40:41], v[40:41] op_sel:[0,1,1] op_sel_hi:[1,1,1]
    v_pk_fma_f32 v[180:181], v[180:181], v[40:41], v[40:41] op_sel:[0,1,1] op_sel_hi:[1,1,1]
    v_pk_fma_f32 v[182:183], v[182:183], v[40:41], v[40:41] op_sel:[0,1,1] op_sel_hi:[1,1,1]
    v_rcp_f32 v176, v176
    v_rcp_f32 v177, v177
    v_rcp_f32 v178, v178
    v_rcp_f32 v179, v179
    v_rcp_f32 v180, v180
    v_rcp_f32 v181, v181
    v_rcp_f32 v182, v182
    v_rcp_f32 v183, v183
    v_pk_mul_f32 v[96:97], v[96:97], v[176:177]
    v_pk_mul_f32 v[98:99], v[98:99], v[178:179]
    v_pk_mul_f32 v[100:101], v[100:101], v[180:181]
    v_pk_mul_f32 v[102:103], v[102:103], v[182:183]
    v_cvt_pk_bf16_f32 v188, v96, v97
    v_cvt_pk_bf16_f32 v189, v98, v99
    v_cvt_pk_bf16_f32 v190, v100, v101
    v_cvt_pk_bf16_f32 v191, v102, v103
    buffer_store_dwordx4 v[188:191], v224, s[80:83], s17 offen offset:0 sc1
    v_pk_mul_f32 v[176:177], v[112:113], s[24:25] op_sel_hi:[1,0]
    v_pk_mul_f32 v[178:179], v[114:115], s[24:25] op_sel_hi:[1,0]
    v_pk_mul_f32 v[180:181], v[116:117], s[24:25] op_sel_hi:[1,0]
    v_pk_mul_f32 v[182:183], v[118:119], s[24:25] op_sel_hi:[1,0]
    v_exp_f32 v176, v176
    v_exp_f32 v177, v177
    v_exp_f32 v178, v178
    v_exp_f32 v179, v179
    v_exp_f32 v180, v180
    v_exp_f32 v181, v181
    v_exp_f32 v182, v182
    v_exp_f32 v183, v183
    v_pk_mul_f32 v[112:113], v[112:113], v[120:121]
    v_pk_mul_f32 v[114:115], v[114:115], v[122:123]
    v_pk_mul_f32 v[116:117], v[116:117], v[124:125]
    v_pk_mul_f32 v[118:119], v[118:119], v[126:127]
    v_pk_fma_f32 v[176:177], v[176:177], v[40:41], v[40:41] op_sel_hi:[1,0,0]
    v_pk_fma_f32 v[178:179], v[178:179], v[40:41], v[40:41] op_sel_hi:[1,0,0]
    v_pk_fma_f32 v[180:181], v[180:181], v[40:41], v[40:41] op_sel_hi:[1,0,0]
    v_pk_fma_f32 v[182:183], v[182:183], v[40:41], v[40:41] op_sel_hi:[1,0,0]
    v_rcp_f32 v176, v176
    v_rcp_f32 v177, v177
    v_rcp_f32 v178, v178
    v_rcp_f32 v179, v179
    v_rcp_f32 v180, v180
    v_rcp_f32 v181, v181
    v_rcp_f32 v182, v182
    v_rcp_f32 v183, v183
    v_pk_mul_f32 v[112:113], v[112:113], v[176:177]
    v_pk_mul_f32 v[114:115], v[114:115], v[178:179]
    v_pk_mul_f32 v[116:117], v[116:117], v[180:181]
    v_pk_mul_f32 v[118:119], v[118:119], v[182:183]
    v_cvt_pk_bf16_f32 v192, v112, v113
    v_cvt_pk_bf16_f32 v193, v114, v115
    v_cvt_pk_bf16_f32 v194, v116, v117
    v_cvt_pk_bf16_f32 v195, v118, v119
    buffer_store_dwordx4 v[192:195], v224, s[80:83], s16 offen offset:1024 sc1
    v_pk_mul_f32 v[176:177], v[128:129], s[24:25] op_sel_hi:[1,0]
    v_pk_mul_f32 v[178:179], v[130:131], s[24:25] op_sel_hi:[1,0]
    v_pk_mul_f32 v[180:181], v[132:133], s[24:25] op_sel_hi:[1,0]
    v_pk_mul_f32 v[182:183], v[134:135], s[24:25] op_sel_hi:[1,0]
    v_exp_f32 v176, v176
    v_exp_f32 v177, v177
    v_exp_f32 v178, v178
    v_exp_f32 v179, v179
    v_exp_f32 v180, v180
    v_exp_f32 v181, v181
    v_exp_f32 v182, v182
    v_exp_f32 v183, v183
    v_pk_mul_f32 v[128:129], v[128:129], v[136:137]
    v_pk_mul_f32 v[130:131], v[130:131], v[138:139]
    v_pk_mul_f32 v[132:133], v[132:133], v[140:141]
    v_pk_mul_f32 v[134:135], v[134:135], v[142:143]
    v_pk_fma_f32 v[176:177], v[176:177], v[40:41], v[40:41] op_sel:[0,1,1] op_sel_hi:[1,1,1]
    v_pk_fma_f32 v[178:179], v[178:179], v[40:41], v[40:41] op_sel:[0,1,1] op_sel_hi:[1,1,1]
    v_pk_fma_f32 v[180:181], v[180:181], v[40:41], v[40:41] op_sel:[0,1,1] op_sel_hi:[1,1,1]
    v_pk_fma_f32 v[182:183], v[182:183], v[40:41], v[40:41] op_sel:[0,1,1] op_sel_hi:[1,1,1]
    v_rcp_f32 v176, v176
    v_rcp_f32 v177, v177
    v_rcp_f32 v178, v178
    v_rcp_f32 v179, v179
    v_rcp_f32 v180, v180
    v_rcp_f32 v181, v181
    v_rcp_f32 v182, v182
    v_rcp_f32 v183, v183
    v_pk_mul_f32 v[128:129], v[128:129], v[176:177]
    v_pk_mul_f32 v[130:131], v[130:131], v[178:179]
    v_pk_mul_f32 v[132:133], v[132:133], v[180:181]
    v_pk_mul_f32 v[134:135], v[134:135], v[182:183]
    v_cvt_pk_bf16_f32 v196, v128, v129
    v_cvt_pk_bf16_f32 v197, v130, v131
    v_cvt_pk_bf16_f32 v198, v132, v133
    v_cvt_pk_bf16_f32 v199, v134, v135
    s_mov_b32 s39, 0
    s_waitcnt vmcnt(3)
L_fs_chk:
    v_cmp_ne_u32 vcc, s10, v242
    s_nop 1
    s_cbranch_vccz L_fs_ok
    s_add_u32 s39, s39, 1
    s_cmp_gt_u32 s39, 200000
    s_cbranch_scc1 L_fs_ok
    s_sleep 1
    buffer_load_dword v242, v38, s[80:83], 0 offen offset:0 sc1
    s_waitcnt vmcnt(0)
    s_branch L_fs_chk
L_fs_ok:
    s_add_u32 s20, s26, 0
    s_add_u32 s21, s27, 0
    buffer_load_dwordx4 a[192:195], v4, s[80:83], s20 offen offset:0 sc1
    buffer_load_dwordx4 a[196:199], v4, s[80:83], s21 offen offset:0 sc1
    buffer_load_dwordx4 a[200:203], v4, s[80:83], s20 offen offset:1024 sc1
    buffer_load_dwordx4 a[204:207], v4, s[80:83], s21 offen offset:1024 sc1
    buffer_load_dwordx4 a[208:211], v4, s[80:83], s20 offen offset:2048 sc1
    buffer_load_dwordx4 a[212:215], v4, s[80:83], s21 offen offset:2048 sc1
    buffer_load_dwordx4 a[216:219], v4, s[80:83], s20 offen offset:3072 sc1
    buffer_load_dwordx4 a[220:223], v4, s[80:83], s21 offen offset:3072 sc1
    buffer_store_dwordx4 v[196:199], v224, s[80:83], s17 offen offset:1024 sc1
    v_pk_mul_f32 v[176:177], v[144:145], s[24:25] op_sel_hi:[1,0]
    v_pk_mul_f32 v[178:179], v[146:147], s[24:25] op_sel_hi:[1,0]
    v_pk_mul_f32 v[180:181], v[148:149], s[24:25] op_sel_hi:[1,0]
    v_pk_mul_f32 v[182:183], v[150:151], s[24:25] op_sel_hi:[1,0]
    v_exp_f32 v176, v176
    v_exp_f32 v177, v177
    v_exp_f32 v178, v178
    v_exp_f32 v179, v179
    v_exp_f32 v180, v180
    v_exp_f32 v181, v181
    v_exp_f32 v182, v182
    v_exp_f32 v183, v183
    v_pk_mul_f32 v[144:145], v[144:145], v[152:153]
    v_pk_mul_f32 v[146:147], v[146:147], v[154:155]
    v_pk_mul_f32 v[148:149], v[148:149], v[156:157]
    v_pk_mul_f32 v[150:151], v[150:151], v[158:159]
    v_pk_fma_f32 v[176:177], v[176:177], v[40:41], v[40:41] op_sel_hi:[1,0,0]
    v_pk_fma_f32 v[178:179], v[178:179], v[40:41], v[40:41] op_sel_hi:[1,0,0]
    v_pk_fma_f32 v[180:181], v[180:181], v[40:41], v[40:41] op_sel_hi:[1,0,0]
    v_pk_fma_f32 v[182:183], v[182:183], v[40:41], v[40:41] op_sel_hi:[1,0,0]
    v_rcp_f32 v176, v176
    v_rcp_f32 v177, v177
    v_rcp_f32 v178, v178
    v_rcp_f32 v179, v179
    v_rcp_f32 v180, v180
    v_rcp_f32 v181, v181
    v_rcp_f32 v182, v182
    v_rcp_f32 v183, v183
    v_pk_mul_f32 v[144:145], v[144:145], v[176:177]
    v_pk_mul_f32 v[146:147], v[146:147], v[178:179]
    v_pk_mul_f32 v[148:149], v[148:149], v[180:181]
    v_pk_mul_f32 v[150:151], v[150:151], v[182:183]
    v_cvt_pk_bf16_f32 v200, v144, v145
    v_cvt_pk_bf16_f32 v201, v146, v147
    v_cvt_pk_bf16_f32 v202, v148, v149
    v_cvt_pk_bf16_f32 v203, v150, v151
    buffer_store_dwordx4 v[200:203], v224, s[80:83], s16 offen offset:2048 sc1
    v_pk_mul_f32 v[176:177], v[160:161], s[24:25] op_sel_hi:[1,0]
    v_pk_mul_f32 v[178:179], v[162:163], s[24:25] op_sel_hi:[1,0]
    v_pk_mul_f32 v[180:181], v[164:165], s[24:25] op_sel_hi:[1,0]
    v_pk_mul_f32 v[182:183], v[166:167], s[24:25] op_sel_hi:[1,0]
    v_exp_f32 v176, v176
    v_exp_f32 v177, v177
    v_exp_f32 v178, v178
    v_exp_f32 v179, v179
    v_exp_f32 v180, v180
    v_exp_f32 v181, v181
    v_exp_f32 v182, v182
    v_exp_f32 v183, v183
    v_pk_mul_f32 v[160:161], v[160:161], v[168:169]
    v_pk_mul_f32 v[162:163], v[162:163], v[170:171]
    v_pk_mul_f32 v[164:165], v[164:165], v[172:173]
    v_pk_mul_f32 v[166:167], v[166:167], v[174:175]
    v_pk_fma_f32 v[176:177], v[176:177], v[40:41], v[40:41] op_sel:[0,1,1] op_sel_hi:[1,1,1]
    v_pk_fma_f32 v[178:179], v[178:179], v[40:41], v[40:41] op_sel:[0,1,1] op_sel_hi:[1,1,1]
    v_pk_fma_f32 v[180:181], v[180:181], v[40:41], v[40:41] op_sel:[0,1,1] op_sel_hi:[1,1,1]
    v_pk_fma_f32 v[182:183], v[182:183], v[40:41], v[40:41] op_sel:[0,1,1] op_sel_hi:[1,1,1]
    v_rcp_f32 v176, v176
    v_rcp_f32 v177, v177
    v_rcp_f32 v178, v178
    v_rcp_f32 v179, v179
    v_rcp_f32 v180, v180
    v_rcp_f32 v181, v181
    v_rcp_f32 v182, v182
    v_rcp_f32 v183, v183
    v_pk_mul_f32 v[160:161], v[160:161], v[176:177]
    v_pk_mul_f32 v[162:163], v[162:163], v[178:179]
    v_pk_mul_f32 v[164:165], v[164:165], v[180:181]
    v_pk_mul_f32 v[166:167], v[166:167], v[182:183]
    v_cvt_pk_bf16_f32 v204, v160, v161
    v_cvt_pk_bf16_f32 v205, v162, v163
    v_cvt_pk_bf16_f32 v206, v164, v165
    v_cvt_pk_bf16_f32 v207, v166, v167
    buffer_store_dwordx4 v[204:207], v224, s[80:83], s17 offen offset:2048 sc1
    v_add_u32 v228, 65536, v16
    v_add_u32 v230, 65536, v17
    v_add_u32 v229, 131072, v16
    v_add_u32 v231, 131072, v17
    s_lshl_b32 s13, s5, 7
    s_lshl_b32 s12, s8, 6
    s_add_u32 s13, s13, s12
    s_lshr_b32 s12, s4, 1
    s_lshl_b32 s12, s12, 5
    s_add_u32 s13, s13, s12
    s_and_b32 s12, s4, 1
    s_lshl_b32 s12, s12, 3
    s_add_u32 s13, s13, s12
    v_lshrrev_b32 v78, 4, v1
    v_add_u32 v78, s13, v78
    v_and_b32 v79, 15, v1
    s_lshl_b32 s12, s7, 7
    v_lshl_add_u32 v79, v79, 3, s12
    v_lshl_add_u32 v74, v78, 10, v79
    v_lshlrev_b32 v75, 1, v74
    s_lshl_b32 s13, s6, 2
    s_add_u32 s13, s13, s4
    s_xor_b32 s12, s5, 15
    s_or_b32 s13, s13, s12
    v_or_b32 v76, s13, v1
    v_cmp_eq_u32 vcc, 0, v76
    v_mov_b32 v76, 0x80000000
    s_nop 0
    v_cndmask_b32 v76, v76, 0, vcc
    s_waitcnt lgkmcnt(0)
    s_waitcnt vmcnt(9)
    v_mfma_f32_32x32x16_bf16 v[80:95], a[0:3], a[192:195], 0
    v_lshrrev_b32 v224, 4, v2
    v_lshlrev_b32 v224, 14, v224
    v_and_b32 v225, 15, v2
    v_mfma_f32_32x32x16_bf16 v[96:111], a[0:3], a[196:199], 0
    v_lshl_add_u32 v224, v225, 8, v224
    v_and_b32 v225, 7, v2
    v_lshlrev_b32 v225, 4, v225
    s_add_u32 s20, s26, 4096
    s_add_u32 s21, s27, 4096
    buffer_load_dwordx4 a[224:227], v4, s[80:83], s20 offen offset:0 sc1
    buffer_load_dwordx4 a[228:231], v4, s[80:83], s21 offen offset:0 sc1
    buffer_load_dwordx4 a[232:235], v4, s[80:83], s20 offen offset:1024 sc1
    buffer_load_dwordx4 a[236:239], v4, s[80:83], s21 offen offset:1024 sc1
    v_mfma_f32_32x32x16_bf16 v[112:127], a[16:19], a[192:195], 0
    v_xor_b32 v225, v225, v3
    v_add3_u32 v212, v224, v225, s50
    v_mfma_f32_32x32x16_bf16 v[128:143], a[16:19], a[196:199], 0
    v_xor_b32 v213, 32, v212
    v_xor_b32 v214, 64, v212
    v_xor_b32 v215, 96, v212
    s_waitcnt vmcnt(11)
    v_mfma_f32_32x32x16_bf16 v[80:95], a[4:7], a[200:203], v[80:95]
    v_lshrrev_b32 v224, 4, v1
    v_and_b32 v225, 15, v1
    v_xor_b32 v225, v225, v224
    v_mfma_f32_32x32x16_bf16 v[96:111], a[4:7], a[204:207], v[96:111]
    v_lshlrev_b32 v225, 4, v225
    v_lshl_add_u32 v225, v224, 8, v225
    buffer_load_dwordx4 a[240:243], v4, s[80:83], s20 offen offset:2048 sc1
    buffer_load_dwordx4 a[244:247], v4, s[80:83], s21 offen offset:2048 sc1
    buffer_load_dwordx4 a[248:251], v4, s[80:83], s20 offen offset:3072 sc1
    buffer_load_dwordx4 a[252:255], v4, s[80:83], s21 offen offset:3072 sc1
    v_mfma_f32_32x32x16_bf16 v[112:127], a[20:23], a[200:203], v[112:127]
    s_lshl_b32 s12, s4, 14
    s_add_u32 s12, s12, 8192
    v_add_u32 v248, s12, v225
    v_xor_b32 v249, 64, v248
    v_mfma_f32_32x32x16_bf16 v[128:143], a[20:23], a[204:207], v[128:143]
    s_lshl_b32 s13, s8, 8
    s_lshl_b32 s12, s4, 6
    s_add_u32 s12, s12, s13
    v_lshl_add_u32 v224, v224, 2, s12
    s_waitcnt vmcnt(13)
    v_mfma_f32_32x32x16_bf16 v[80:95], a[64:67], a[208:211], v[80:95]
    ds_read_b32 v216, v224 offset:5120
    ds_read_b32 v217, v224 offset:5136
    ds_read_b32 v218, v224 offset:5152
    ds_read_b32 v219, v224 offset:5168
    v_mfma_f32_32x32x16_bf16 v[96:111], a[64:67], a[212:215], v[96:111]
    s_add_u32 s20, s26, 8192
    s_add_u32 s21, s27, 8192
    buffer_load_dwordx4 a[192:195], v4, s[80:83], s20 offen offset:0 sc1
    buffer_load_dwordx4 a[196:199], v4, s[80:83], s21 offen offset:0 sc1
    buffer_load_dwordx4 a[200:203], v4, s[80:83], s20 offen offset:1024 sc1
    buffer_load_dwordx4 a[204:207], v4, s[80:83], s21 offen offset:1024 sc1
    v_mfma_f32_32x32x16_bf16 v[112:127], a[80:83], a[208:211], v[112:127]
    v_mfma_f32_32x32x16_bf16 v[128:143], a[80:83], a[212:215], v[128:143]
    s_waitcnt vmcnt(12)
    buffer_store_dword v245, v244, s[80:83], 0 offen offset:128 sc1
    v_mfma_f32_32x32x16_bf16 v[80:95], a[68:71], a[216:219], v[80:95]
    v_mfma_f32_32x32x16_bf16 v[96:111], a[68:71], a[220:223], v[96:111]
    buffer_load_dwordx4 a[208:211], v4, s[80:83], s20 offen offset:2048 sc1
    buffer_load_dwordx4 a[212:215], v4, s[80:83], s21 offen offset:2048 sc1
    v_mfma_f32_32x32x16_bf16 v[112:127], a[84:87], a[216:219], v[112:127]
    v_mfma_f32_32x32x16_bf16 v[128:143], a[84:87], a[220:223], v[128:143]
    s_waitcnt vmcnt(13)
    v_mfma_f32_32x32x16_bf16 v[80:95], a[8:11], a[224:227], v[80:95]
    v_mfma_f32_32x32x16_bf16 v[96:111], a[8:11], a[228:231], v[96:111]
    buffer_load_dwordx4 a[216:219], v4, s[80:83], s20 offen offset:3072 sc1
    buffer_load_dwordx4 a[220:223], v4, s[80:83], s21 offen offset:3072 sc1
    v_mfma_f32_32x32x16_bf16 v[112:127], a[24:27], a[224:227], v[112:127]
    v_mfma_f32_32x32x16_bf16 v[128:143], a[24:27], a[228:231], v[128:143]
    buffer_load_dwordx4 v44, s[76:79], s51 offen offset:2048 lds
    buffer_load_dwordx4 v45, s[76:79], s51 offen offset:3072 lds
    s_add_u32 s51, s35, 229376
    s_add_u32 m0, s50, 114688
    s_nop 0
    buffer_load_dwordx4 v42, s[76:79], s51 offen offset:0 lds
    s_waitcnt vmcnt(16)
    v_mfma_f32_32x32x16_bf16 v[80:95], a[12:15], a[232:235], v[80:95]
    v_mfma_f32_32x32x16_bf16 v[96:111], a[12:15], a[236:239], v[96:111]
    s_add_u32 s20, s26, 12288
    s_add_u32 s21, s27, 12288
    buffer_load_dwordx4 a[224:227], v4, s[80:83], s20 offen offset:0 sc1
    buffer_load_dwordx4 a[228:231], v4, s[80:83], s21 offen offset:0 sc1
    v_mfma_f32_32x32x16_bf16 v[112:127], a[28:31], a[232:235], v[112:127]
    v_mfma_f32_32x32x16_bf16 v[128:143], a[28:31], a[236:239], v[128:143]
    buffer_load_dwordx4 v43, s[76:79], s51 offen offset:1024 lds
    buffer_load_dwordx4 v44, s[76:79], s51 offen offset:2048 lds
    buffer_load_dwordx4 v45, s[76:79], s51 offen offset:3072 lds
    s_waitcnt vmcnt(19)
    v_mfma_f32_32x32x16_bf16 v[80:95], a[72:75], a[240:243], v[80:95]
    v_mfma_f32_32x32x16_bf16 v[96:111], a[72:75], a[244:247], v[96:111]
    buffer_load_dwordx4 a[232:235], v4, s[80:83], s20 offen offset:1024 sc1
    buffer_load_dwordx4 a[236:239], v4, s[80:83], s21 offen offset:1024 sc1
    v_mfma_f32_32x32x16_bf16 v[112:127], a[88:91], a[240:243], v[112:127]
    v_mfma_f32_32x32x16_bf16 v[128:143], a[88:91], a[244:247], v[128:143]
    s_add_u32 s51, s35, 262144
    s_add_u32 m0, s50, 81920
    s_nop 0
    buffer_load_dwordx4 v42, s[76:79], s51 offen offset:0 lds
    buffer_load_dwordx4 v43, s[76:79], s51 offen offset:1024 lds
    buffer_load_dwordx4 v44, s[76:79], s51 offen offset:2048 lds
    s_waitcnt vmcnt(22)
    v_mfma_f32_32x32x16_bf16 v[80:95], a[76:79], a[248:251], v[80:95]
    v_mfma_f32_32x32x16_bf16 v[96:111], a[76:79], a[252:255], v[96:111]
    buffer_load_dwordx4 a[240:243], v4, s[80:83], s20 offen offset:2048 sc1
    buffer_load_dwordx4 a[244:247], v4, s[80:83], s21 offen offset:2048 sc1
    v_mfma_f32_32x32x16_bf16 v[112:127], a[92:95], a[248:251], v[112:127]
    v_mfma_f32_32x32x16_bf16 v[128:143], a[92:95], a[252:255], v[128:143]
    buffer_load_dwordx4 v45, s[76:79], s51 offen offset:3072 lds
    s_add_u32 s51, s35, 294912
    s_add_u32 m0, s50, 98304
    s_nop 0
    buffer_load_dwordx4 v42, s[76:79], s51 offen offset:0 lds
    buffer_load_dwordx4 v43, s[76:79], s51 offen offset:1024 lds
    s_waitcnt vmcnt(25)
    v_mfma_f32_32x32x16_bf16 v[80:95], a[32:35], a[192:195], v[80:95]
    v_mfma_f32_32x32x16_bf16 v[96:111], a[32:35], a[196:199], v[96:111]
    buffer_load_dwordx4 a[248:251], v4, s[80:83], s20 offen offset:3072 sc1
    buffer_load_dwordx4 a[252:255], v4, s[80:83], s21 offen offset:3072 sc1
    buffer_load_dword v243, v12, s[80:83], 0 offen offset:128 sc1
    v_mfma_f32_32x32x16_bf16 v[112:127], a[48:51], a[192:195], v[112:127]
    v_mfma_f32_32x32x16_bf16 v[128:143], a[48:51], a[196:199], v[128:143]
    buffer_load_dwordx4 v44, s[76:79], s51 offen offset:2048 lds
    buffer_load_dwordx4 v45, s[76:79], s51 offen offset:3072 lds
    s_add_u32 s51, s35, 327680
    s_add_u32 m0, s50, 131072
    s_nop 0
    buffer_load_dwordx4 v42, s[76:79], s51 offen offset:0 lds
    s_waitcnt vmcnt(29)
    v_mfma_f32_32x32x16_bf16 v[80:95], a[36:39], a[200:203], v[80:95]
    v_mfma_f32_32x32x16_bf16 v[96:111], a[36:39], a[204:207], v[96:111]
    v_mfma_f32_32x32x16_bf16 v[112:127], a[52:55], a[200:203], v[112:127]
    v_mfma_f32_32x32x16_bf16 v[128:143], a[52:55], a[204:207], v[128:143]
    buffer_load_dwordx4 v43, s[76:79], s51 offen offset:1024 lds
    buffer_load_dwordx4 v44, s[76:79], s51 offen offset:2048 lds
    buffer_load_dwordx4 v45, s[76:79], s51 offen offset:3072 lds
    global_load_dwordx2 v[72:73], v79, s[32:33]
    s_movk_i32 s14, 0
    buffer_load_dwordx2 v[64:65], v74, s[52:55], s14 offen
    s_movk_i32 s14, 16384
    buffer_load_dwordx2 v[66:67], v74, s[52:55], s14 offen
    s_movk_i32 s14, 4096
    buffer_load_dwordx2 v[68:69], v74, s[52:55], s14 offen
    s_movk_i32 s14, 20480
    buffer_load_dwordx2 v[70:71], v74, s[52:55], s14 offen
    s_waitcnt vmcnt(34)
    v_mfma_f32_32x32x16_bf16 v[80:95], a[96:99], a[208:211], v[80:95]
    v_mfma_f32_32x32x16_bf16 v[96:111], a[96:99], a[212:215], v[96:111]
    v_mfma_f32_32x32x16_bf16 v[112:127], a[112:115], a[208:211], v[112:127]
    v_mfma_f32_32x32x16_bf16 v[128:143], a[112:115], a[212:215], v[128:143]
    s_waitcnt vmcnt(32)
    v_mfma_f32_32x32x16_bf16 v[80:95], a[100:103], a[216:219], v[80:95]
    v_mfma_f32_32x32x16_bf16 v[96:111], a[100:103], a[220:223], v[96:111]
    v_mfma_f32_32x32x16_bf16 v[112:127], a[116:119], a[216:219], v[112:127]
    v_mfma_f32_32x32x16_bf16 v[128:143], a[116:119], a[220:223], v[128:143]
    s_waitcnt vmcnt(27)
    v_mfma_f32_32x32x16_bf16 v[80:95], a[40:43], a[224:227], v[80:95]
    v_mfma_f32_32x32x16_bf16 v[96:111], a[40:43], a[228:231], v[96:111]
    s_mov_b32 s39, 0
    s_waitcnt vmcnt(11)
L_ff_chk:
    v_cmp_ne_u32 vcc, s10, v243
    s_nop 1
    s_cbranch_vccz L_ff_ok
    s_add_u32 s39, s39, 1
    s_cmp_gt_u32 s39, 200000
    s_cbranch_scc1 L_ff_ok
    s_sleep 1
    buffer_load_dword v243, v12, s[80:83], 0 offen offset:128 sc1
    s_waitcnt vmcnt(0)
    s_branch L_ff_chk
L_ff_ok:
    s_add_u32 s20, s28, 0
    s_add_u32 s21, s29, 0
    buffer_load_dwordx4 a[192:195], v4, s[80:83], s20 offen offset:0 sc1
    buffer_load_dwordx4 a[196:199], v4, s[80:83], s21 offen offset:0 sc1
    buffer_load_dwordx4 a[200:203], v4, s[80:83], s20 offen offset:1024 sc1
    buffer_load_dwordx4 a[204:207], v4, s[80:83], s21 offen offset:1024 sc1
    v_mfma_f32_32x32x16_bf16 v[112:127], a[56:59], a[224:227], v[112:127]
    v_mfma_f32_32x32x16_bf16 v[128:143], a[56:59], a[228:231], v[128:143]
    v_mfma_f32_32x32x16_bf16 v[80:95], a[44:47], a[232:235], v[80:95]
    v_mfma_f32_32x32x16_bf16 v[96:111], a[44:47], a[236:239], v[96:111]
    buffer_load_dwordx4 a[208:211], v4, s[80:83], s20 offen offset:2048 sc1
    buffer_load_dwordx4 a[212:215], v4, s[80:83], s21 offen offset:2048 sc1
    buffer_load_dwordx4 a[216:219], v4, s[80:83], s20 offen offset:3072 sc1
    buffer_load_dwordx4 a[220:223], v4, s[80:83], s21 offen offset:3072 sc1
    v_mfma_f32_32x32x16_bf16 v[112:127], a[60:63], a[232:235], v[112:127]
    v_mfma_f32_32x32x16_bf16 v[128:143], a[60:63], a[236:239], v[128:143]
    v_mfma_f32_32x32x16_bf16 v[80:95], a[104:107], a[240:243], v[80:95]
    v_mfma_f32_32x32x16_bf16 v[96:111], a[104:107], a[244:247], v[96:111]
    s_add_u32 s20, s28, 4096
    s_add_u32 s21, s29, 4096
    buffer_load_dwordx4 a[224:227], v4, s[80:83], s20 offen offset:0 sc1
    buffer_load_dwordx4 a[228:231], v4, s[80:83], s21 offen offset:0 sc1
    buffer_load_dwordx4 a[232:235], v4, s[80:83], s20 offen offset:1024 sc1
    buffer_load_dwordx4 a[236:239], v4, s[80:83], s21 offen offset:1024 sc1
    v_mfma_f32_32x32x16_bf16 v[112:127], a[120:123], a[240:243], v[112:127]
    s_waitcnt vmcnt(12)
    v_lshlrev_b32 v250, 16, v72
    v_and_b32 v251, 0xffff0000, v72
    v_mfma_f32_32x32x16_bf16 v[128:143], a[120:123], a[244:247], v[128:143]
    v_lshlrev_b32 v252, 16, v73
    v_and_b32 v253, 0xffff0000, v73
    v_mfma_f32_32x32x16_bf16 v[80:95], a[108:111], a[248:251], v[80:95]
    s_waitcnt lgkmcnt(0)
    v_lshlrev_b32 v48, 16, v64
    v_and_b32 v49, 0xffff0000, v64
    v_mul_f32 v48, v48, v250
    v_mfma_f32_32x32x16_bf16 v[96:111], a[108:111], a[252:255], v[96:111]
    v_mul_f32 v49, v49, v251
    v_cvt_pk_bf16_f32 v49, v48, v49
    v_lshlrev_b32 v48, 16, v49
    buffer_load_dwordx4 a[240:243], v4, s[80:83], s20 offen offset:2048 sc1
    buffer_load_dwordx4 a[244:247], v4, s[80:83], s21 offen offset:2048 sc1
    v_mfma_f32_32x32x16_bf16 v[112:127], a[124:127], a[248:251], v[112:127]
    v_and_b32 v49, 0xffff0000, v49
    v_mul_f32 v48, v48, v216
    v_mul_f32 v49, v49, v216
    v_mfma_f32_32x32x16_bf16 v[128:143], a[124:127], a[252:255], v[128:143]
    v_lshlrev_b32 v50, 16, v65
    v_and_b32 v51, 0xffff0000, v65
    v_mul_f32 v50, v50, v252
    s_waitcnt vmcnt(12)
    v_mfma_f32_32x32x16_bf16 v[80:95], a[128:131], a[192:195], v[80:95]
    v_mul_f32 v51, v51, v253
    v_cvt_pk_bf16_f32 v51, v50, v51
    v_lshlrev_b32 v50, 16, v51
    v_mfma_f32_32x32x16_bf16 v[96:111], a[128:131], a[196:199], v[96:111]
    v_and_b32 v51, 0xffff0000, v51
    v_mul_f32 v50, v50, v216
    v_mul_f32 v51, v51, v216
    buffer_load_dwordx4 a[248:251], v4, s[80:83], s20 offen offset:3072 sc1
    buffer_load_dwordx4 a[252:255], v4, s[80:83], s21 offen offset:3072 sc1
    v_mfma_f32_32x32x16_bf16 v[112:127], a[132:135], a[192:195], v[112:127]
    v_lshlrev_b32 v52, 16, v66
    v_and_b32 v53, 0xffff0000, v66
    v_mul_f32 v52, v52, v250
    v_mfma_f32_32x32x16_bf16 v[128:143], a[132:135], a[196:199], v[128:143]
    v_mul_f32 v53, v53, v251
    v_cvt_pk_bf16_f32 v53, v52, v53
    v_lshlrev_b32 v52, 16, v53
    s_waitcnt vmcnt(12)
    v_mfma_f32_32x32x16_bf16 v[80:95], a[136:139], a[200:203], v[80:95]
    v_and_b32 v53, 0xffff0000, v53
    v_mul_f32 v52, v52, v217
    v_mul_f32 v53, v53, v217
    v_mfma_f32_32x32x16_bf16 v[96:111], a[136:139], a[204:207], v[96:111]
    v_lshlrev_b32 v54, 16, v67
    v_and_b32 v55, 0xffff0000, v67
    v_mul_f32 v54, v54, v252
    s_add_u32 s20, s28, 8192
    s_add_u32 s21, s29, 8192
    buffer_load_dwordx4 a[192:195], v4, s[80:83], s20 offen offset:0 sc1
    buffer_load_dwordx4 a[196:199], v4, s[80:83], s21 offen offset:0 sc1
    v_mfma_f32_32x32x16_bf16 v[112:127], a[140:143], a[200:203], v[112:127]
    v_mul_f32 v55, v55, v253
    v_cvt_pk_bf16_f32 v55, v54, v55
    v_lshlrev_b32 v54, 16, v55
    v_mfma_f32_32x32x16_bf16 v[128:143], a[140:143], a[204:207], v[128:143]
    v_and_b32 v55, 0xffff0000, v55
    v_mul_f32 v54, v54, v217
    v_mul_f32 v55, v55, v217
    s_waitcnt vmcnt(12)
    v_mfma_f32_32x32x16_bf16 v[80:95], a[144:147], a[208:211], v[80:95]
    v_lshlrev_b32 v56, 16, v68
    v_and_b32 v57, 0xffff0000, v68
    v_mul_f32 v56, v56, v250
    v_mfma_f32_32x32x16_bf16 v[96:111], a[144:147], a[212:215], v[96:111]
    v_mul_f32 v57, v57, v251
    v_cvt_pk_bf16_f32 v57, v56, v57
    v_lshlrev_b32 v56, 16, v57
    buffer_load_dwordx4 a[200:203], v4, s[80:83], s20 offen offset:1024 sc1
    buffer_load_dwordx4 a[204:207], v4, s[80:83], s21 offen offset:1024 sc1
    v_mfma_f32_32x32x16_bf16 v[112:127], a[148:151], a[208:211], v[112:127]
    v_and_b32 v57, 0xffff0000, v57
    v_mul_f32 v56, v56, v218
    v_mul_f32 v57, v57, v218
    v_mfma_f32_32x32x16_bf16 v[128:143], a[148:151], a[212:215], v[128:143]
    v_lshlrev_b32 v58, 16, v69
    v_and_b32 v59, 0xffff0000, v69
    v_mul_f32 v58, v58, v252
    s_waitcnt vmcnt(12)
    v_mfma_f32_32x32x16_bf16 v[80:95], a[152:155], a[216:219], v[80:95]
    v_mul_f32 v59, v59, v253
    v_cvt_pk_bf16_f32 v59, v58, v59
    v_lshlrev_b32 v58, 16, v59
    v_mfma_f32_32x32x16_bf16 v[96:111], a[152:155], a[220:223], v[96:111]
    v_and_b32 v59, 0xffff0000, v59
    v_mul_f32 v58, v58, v218
    v_mul_f32 v59, v59, v218
    buffer_load_dwordx4 a[208:211], v4, s[80:83], s20 offen offset:2048 sc1
    buffer_load_dwordx4 a[212:215], v4, s[80:83], s21 offen offset:2048 sc1
    v_mfma_f32_32x32x16_bf16 v[112:127], a[156:159], a[216:219], v[112:127]
    v_lshlrev_b32 v60, 16, v70
    v_and_b32 v61, 0xffff0000, v70
    v_mul_f32 v60, v60, v250
    v_mfma_f32_32x32x16_bf16 v[128:143], a[156:159], a[220:223], v[128:143]
    v_mul_f32 v61, v61, v251
    v_cvt_pk_bf16_f32 v61, v60, v61
    v_lshlrev_b32 v60, 16, v61
    ds_read_b64_tr_b16 v[192:193], v16 offset:49152
    ds_read_b64_tr_b16 v[194:195], v16 offset:50176
    ds_read_b64_tr_b16 v[196:197], v17 offset:49152
    ds_read_b64_tr_b16 v[198:199], v17 offset:50176
    s_waitcnt vmcnt(12)
    v_mfma_f32_32x32x16_bf16 v[80:95], a[160:163], a[224:227], v[80:95]
    v_and_b32 v61, 0xffff0000, v61
    v_mul_f32 v60, v60, v219
    v_mul_f32 v61, v61, v219
    v_mfma_f32_32x32x16_bf16 v[96:111], a[160:163], a[228:231], v[96:111]
    v_lshlrev_b32 v62, 16, v71
    v_and_b32 v63, 0xffff0000, v71
    v_mul_f32 v62, v62, v252
    buffer_load_dwordx4 a[216:219], v4, s[80:83], s20 offen offset:3072 sc1
    buffer_load_dwordx4 a[220:223], v4, s[80:83], s21 offen offset:3072 sc1
    v_mfma_f32_32x32x16_bf16 v[112:127], a[164:167], a[224:227], v[112:127]
    v_mul_f32 v63, v63, v253
    v_cvt_pk_bf16_f32 v63, v62, v63
    v_lshlrev_b32 v62, 16, v63
    v_mfma_f32_32x32x16_bf16 v[128:143], a[164:167], a[228:231], v[128:143]
    v_and_b32 v63, 0xffff0000, v63
    v_mul_f32 v62, v62, v219
    v_mul_f32 v63, v63, v219
    ds_read_b64_tr_b16 v[200:201], v16 offset:51200
    ds_read_b64_tr_b16 v[202:203], v16 offset:52224
    ds_read_b64_tr_b16 v[204:205], v17 offset:51200
    ds_read_b64_tr_b16 v[206:207], v17 offset:52224
    s_waitcnt vmcnt(12)
    v_mfma_f32_32x32x16_bf16 v[80:95], a[168:171], a[232:235], v[80:95]
    v_mfma_f32_32x32x16_bf16 v[96:111], a[168:171], a[236:239], v[96:111]
    s_add_u32 s20, s28, 12288
    s_add_u32 s21, s29, 12288
    buffer_load_dwordx4 a[224:227], v4, s[80:83], s20 offen offset:0 sc1
    buffer_load_dwordx4 a[228:231], v4, s[80:83], s21 offen offset:0 sc1
    v_mfma_f32_32x32x16_bf16 v[112:127], a[172:175], a[232:235], v[112:127]
    v_mfma_f32_32x32x16_bf16 v[128:143], a[172:175], a[236:239], v[128:143]
    ds_read_b64_tr_b16 v[176:177], v228 offset:0
    ds_read_b64_tr_b16 v[178:179], v228 offset:1024
    ds_read_b64_tr_b16 v[180:181], v230 offset:0
    ds_read_b64_tr_b16 v[182:183], v230 offset:1024
    s_waitcnt vmcnt(12)
    s_waitcnt lgkmcnt(8)
    v_mfma_f32_32x32x16_bf16 v[80:95], v[192:195], a[240:243], v[80:95]
    v_mfma_f32_32x32x16_bf16 v[96:111], v[192:195], a[244:247], v[96:111]
    buffer_load_dwordx4 a[232:235], v4, s[80:83], s20 offen offset:1024 sc1
    buffer_load_dwordx4 a[236:239], v4, s[80:83], s21 offen offset:1024 sc1
    v_mfma_f32_32x32x16_bf16 v[112:127], v[196:199], a[240:243], v[112:127]
    v_mfma_f32_32x32x16_bf16 v[128:143], v[196:199], a[244:247], v[128:143]
    ds_read_b64_tr_b16 v[184:185], v228 offset:2048
    ds_read_b64_tr_b16 v[186:187], v228 offset:3072
    ds_read_b64_tr_b16 v[188:189], v230 offset:2048
    ds_read_b64_tr_b16 v[190:191], v230 offset:3072
    s_waitcnt vmcnt(12)
    s_waitcnt lgkmcnt(8)
    v_mfma_f32_32x32x16_bf16 v[80:95], v[200:203], a[248:251], v[80:95]
    v_mfma_f32_32x32x16_bf16 v[96:111], v[200:203], a[252:255], v[96:111]
    buffer_load_dwordx4 a[240:243], v4, s[80:83], s20 offen offset:2048 sc1
    buffer_load_dwordx4 a[244:247], v4, s[80:83], s21 offen offset:2048 sc1
    v_mfma_f32_32x32x16_bf16 v[112:127], v[204:207], a[248:251], v[112:127]
    v_mfma_f32_32x32x16_bf16 v[128:143], v[204:207], a[252:255], v[128:143]
    ds_read_b64_tr_b16 v[192:193], v16 offset:32768
    ds_read_b64_tr_b16 v[194:195], v16 offset:33792
    ds_read_b64_tr_b16 v[196:197], v17 offset:32768
    ds_read_b64_tr_b16 v[198:199], v17 offset:33792
    s_waitcnt vmcnt(12)
    s_waitcnt lgkmcnt(8)
    v_mfma_f32_32x32x16_bf16 v[80:95], v[176:179], a[192:195], v[80:95]
    v_mfma_f32_32x32x16_bf16 v[96:111], v[176:179], a[196:199], v[96:111]
    buffer_load_dwordx4 a[248:251], v4, s[80:83], s20 offen offset:3072 sc1
    buffer_load_dwordx4 a[252:255], v4, s[80:83], s21 offen offset:3072 sc1
    v_mfma_f32_32x32x16_bf16 v[112:127], v[180:183], a[192:195], v[112:127]
    v_mfma_f32_32x32x16_bf16 v[128:143], v[180:183], a[196:199], v[128:143]
    ds_read_b64_tr_b16 v[200:201], v16 offset:34816
    ds_read_b64_tr_b16 v[202:203], v16 offset:35840
    ds_read_b64_tr_b16 v[204:205], v17 offset:34816
    ds_read_b64_tr_b16 v[206:207], v17 offset:35840
    s_waitcnt vmcnt(12)
    s_waitcnt lgkmcnt(8)
    v_mfma_f32_32x32x16_bf16 v[80:95], v[184:187], a[200:203], v[80:95]
    v_mfma_f32_32x32x16_bf16 v[96:111], v[184:187], a[204:207], v[96:111]
    s_add_u32 s20, s28, 16384
    s_add_u32 s21, s29, 16384
    buffer_load_dwordx4 a[192:195], v4, s[80:83], s20 offen offset:0 sc1
    buffer_load_dwordx4 a[196:199], v4, s[80:83], s21 offen offset:0 sc1
    v_mfma_f32_32x32x16_bf16 v[112:127], v[188:191], a[200:203], v[112:127]
    v_mfma_f32_32x32x16_bf16 v[128:143], v[188:191], a[204:207], v[128:143]
    ds_read_b64_tr_b16 v[176:177], v16 offset:16384
    ds_read_b64_tr_b16 v[178:179], v16 offset:17408
    ds_read_b64_tr_b16 v[180:181], v17 offset:16384
    ds_read_b64_tr_b16 v[182:183], v17 offset:17408
    s_waitcnt vmcnt(12)
    s_waitcnt lgkmcnt(8)
    v_mfma_f32_32x32x16_bf16 v[80:95], v[192:195], a[208:211], v[80:95]
    v_mfma_f32_32x32x16_bf16 v[96:111], v[192:195], a[212:215], v[96:111]
    buffer_load_dwordx4 a[200:203], v4, s[80:83], s20 offen offset:1024 sc1
    buffer_load_dwordx4 a[204:207], v4, s[80:83], s21 offen offset:1024 sc1
    v_mfma_f32_32x32x16_bf16 v[112:127], v[196:199], a[208:211], v[112:127]
    v_mfma_f32_32x32x16_bf16 v[128:143], v[196:199], a[212:215], v[128:143]
    ds_read_b64_tr_b16 v[184:185], v16 offset:18432
    ds_read_b64_tr_b16 v[186:187], v16 offset:19456
    ds_read_b64_tr_b16 v[188:189], v17 offset:18432
    ds_read_b64_tr_b16 v[190:191], v17 offset:19456
    s_waitcnt vmcnt(12)
    s_waitcnt lgkmcnt(8)
    v_mfma_f32_32x32x16_bf16 v[80:95], v[200:203], a[216:219], v[80:95]
    v_mfma_f32_32x32x16_bf16 v[96:111], v[200:203], a[220:223], v[96:111]
    buffer_load_dwordx4 a[208:211], v4, s[80:83], s20 offen offset:2048 sc1
    buffer_load_dwordx4 a[212:215], v4, s[80:83], s21 offen offset:2048 sc1
    v_mfma_f32_32x32x16_bf16 v[112:127], v[204:207], a[216:219], v[112:127]
    v_mfma_f32_32x32x16_bf16 v[128:143], v[204:207], a[220:223], v[128:143]
    ds_read_b64_tr_b16 v[192:193], v228 offset:49152
    ds_read_b64_tr_b16 v[194:195], v228 offset:50176
    ds_read_b64_tr_b16 v[196:197], v230 offset:49152
    ds_read_b64_tr_b16 v[198:199], v230 offset:50176
    s_waitcnt vmcnt(12)
    s_waitcnt lgkmcnt(8)
    v_mfma_f32_32x32x16_bf16 v[80:95], v[176:179], a[224:227], v[80:95]
    v_mfma_f32_32x32x16_bf16 v[96:111], v[176:179], a[228:231], v[96:111]
    buffer_load_dwordx4 a[216:219], v4, s[80:83], s20 offen offset:3072 sc1
    buffer_load_dwordx4 a[220:223], v4, s[80:83], s21 offen offset:3072 sc1
    v_mfma_f32_32x32x16_bf16 v[112:127], v[180:183], a[224:227], v[112:127]
    v_mfma_f32_32x32x16_bf16 v[128:143], v[180:183], a[228:231], v[128:143]
    ds_read_b64_tr_b16 v[200:201], v228 offset:51200
    ds_read_b64_tr_b16 v[202:203], v228 offset:52224
    ds_read_b64_tr_b16 v[204:205], v230 offset:51200
    ds_read_b64_tr_b16 v[206:207], v230 offset:52224
    s_waitcnt vmcnt(12)
    s_waitcnt lgkmcnt(8)
    v_mfma_f32_32x32x16_bf16 v[80:95], v[184:187], a[232:235], v[80:95]
    v_mfma_f32_32x32x16_bf16 v[96:111], v[184:187], a[236:239], v[96:111]
    s_add_u32 s20, s28, 20480
    s_add_u32 s21, s29, 20480
    buffer_load_dwordx4 a[224:227], v4, s[80:83], s20 offen offset:0 sc1
    buffer_load_dwordx4 a[228:231], v4, s[80:83], s21 offen offset:0 sc1
    v_mfma_f32_32x32x16_bf16 v[112:127], v[188:191], a[232:235], v[112:127]
    v_mfma_f32_32x32x16_bf16 v[128:143], v[188:191], a[236:239], v[128:143]
    ds_read_b64_tr_b16 v[176:177], v228 offset:16384
    ds_read_b64_tr_b16 v[178:179], v228 offset:17408
    ds_read_b64_tr_b16 v[180:181], v230 offset:16384
    ds_read_b64_tr_b16 v[182:183], v230 offset:17408
    s_waitcnt vmcnt(12)
    s_waitcnt lgkmcnt(8)
    v_mfma_f32_32x32x16_bf16 v[80:95], v[192:195], a[240:243], v[80:95]
    v_mfma_f32_32x32x16_bf16 v[96:111], v[192:195], a[244:247], v[96:111]
    buffer_load_dwordx4 a[232:235], v4, s[80:83], s20 offen offset:1024 sc1
    buffer_load_dwordx4 a[236:239], v4, s[80:83], s21 offen offset:1024 sc1
    v_mfma_f32_32x32x16_bf16 v[112:127], v[196:199], a[240:243], v[112:127]
    v_mfma_f32_32x32x16_bf16 v[128:143], v[196:199], a[244:247], v[128:143]
    ds_read_b64_tr_b16 v[184:185], v228 offset:18432
    ds_read_b64_tr_b16 v[186:187], v228 offset:19456
    ds_read_b64_tr_b16 v[188:189], v230 offset:18432
    ds_read_b64_tr_b16 v[190:191], v230 offset:19456
    s_waitcnt vmcnt(12)
    s_waitcnt lgkmcnt(8)
    v_mfma_f32_32x32x16_bf16 v[80:95], v[200:203], a[248:251], v[80:95]
    v_mfma_f32_32x32x16_bf16 v[96:111], v[200:203], a[252:255], v[96:111]
    v_mfma_f32_32x32x16_bf16 v[112:127], v[204:207], a[248:251], v[112:127]
    v_mfma_f32_32x32x16_bf16 v[128:143], v[204:207], a[252:255], v[128:143]
    ds_read_b64_tr_b16 v[192:193], v228 offset:32768
    ds_read_b64_tr_b16 v[194:195], v228 offset:33792
    ds_read_b64_tr_b16 v[196:197], v230 offset:32768
    ds_read_b64_tr_b16 v[198:199], v230 offset:33792
    s_waitcnt vmcnt(10)
    s_waitcnt lgkmcnt(8)
    v_mfma_f32_32x32x16_bf16 v[80:95], v[176:179], a[192:195], v[80:95]
    v_mfma_f32_32x32x16_bf16 v[96:111], v[176:179], a[196:199], v[96:111]
    v_mfma_f32_32x32x16_bf16 v[112:127], v[180:183], a[192:195], v[112:127]
    v_mfma_f32_32x32x16_bf16 v[128:143], v[180:183], a[196:199], v[128:143]
    ds_read_b64_tr_b16 v[176:177], v229 offset:0
    ds_read_b64_tr_b16 v[178:179], v229 offset:1024
    ds_read_b64_tr_b16 v[180:181], v231 offset:0
    ds_read_b64_tr_b16 v[182:183], v231 offset:1024
    ds_read_b64_tr_b16 v[200:201], v228 offset:34816
    ds_read_b64_tr_b16 v[202:203], v228 offset:35840
    ds_read_b64_tr_b16 v[204:205], v230 offset:34816
    ds_read_b64_tr_b16 v[206:207], v230 offset:35840
    s_waitcnt vmcnt(8)
    s_waitcnt lgkmcnt(12)
    v_mfma_f32_32x32x16_bf16 v[80:95], v[184:187], a[200:203], v[80:95]
    v_mfma_f32_32x32x16_bf16 v[96:111], v[184:187], a[204:207], v[96:111]
    v_mfma_f32_32x32x16_bf16 v[112:127], v[188:191], a[200:203], v[112:127]
    v_mfma_f32_32x32x16_bf16 v[128:143], v[188:191], a[204:207], v[128:143]
    ds_read_b64_tr_b16 v[184:185], v229 offset:2048
    ds_read_b64_tr_b16 v[186:187], v229 offset:3072
    ds_read_b64_tr_b16 v[188:189], v231 offset:2048
    ds_read_b64_tr_b16 v[190:191], v231 offset:3072
    s_waitcnt vmcnt(6) lgkmcnt(12)
    v_mfma_f32_32x32x16_bf16 v[80:95], v[192:195], a[208:211], v[80:95]
    s_waitcnt vmcnt(4) lgkmcnt(4)
    v_mfma_f32_32x32x16_bf16 v[80:95], v[200:203], a[216:219], v[80:95]
    s_waitcnt vmcnt(2)
    v_mfma_f32_32x32x16_bf16 v[80:95], v[176:179], a[224:227], v[80:95]
    s_waitcnt vmcnt(0) lgkmcnt(0)
    v_mfma_f32_32x32x16_bf16 v[80:95], v[184:187], a[232:235], v[80:95]
    v_mfma_f32_32x32x16_bf16 v[96:111], v[192:195], a[212:215], v[96:111]
    v_mfma_f32_32x32x16_bf16 v[96:111], v[200:203], a[220:223], v[96:111]
    v_mfma_f32_32x32x16_bf16 v[96:111], v[176:179], a[228:231], v[96:111]
    s_nop 8
    ds_write_b128 v212, v[80:83] offset:0
    ds_write_b128 v213, v[84:87] offset:0
    v_mfma_f32_32x32x16_bf16 v[96:111], v[184:187], a[236:239], v[96:111]
    ds_write_b128 v214, v[88:91] offset:0
    ds_write_b128 v215, v[92:95] offset:0
    v_mfma_f32_32x32x16_bf16 v[112:127], v[196:199], a[208:211], v[112:127]
    v_mfma_f32_32x32x16_bf16 v[112:127], v[204:207], a[216:219], v[112:127]
    v_mfma_f32_32x32x16_bf16 v[112:127], v[180:183], a[224:227], v[112:127]
    s_nop 6
    ds_write_b128 v212, v[96:99] offset:32768
    ds_write_b128 v213, v[100:103] offset:32768
    v_mfma_f32_32x32x16_bf16 v[112:127], v[188:191], a[232:235], v[112:127]
    ds_write_b128 v214, v[104:107] offset:32768
    ds_write_b128 v215, v[108:111] offset:32768
    v_mfma_f32_32x32x16_bf16 v[128:143], v[196:199], a[212:215], v[128:143]
    v_mfma_f32_32x32x16_bf16 v[128:143], v[204:207], a[220:223], v[128:143]
    v_mfma_f32_32x32x16_bf16 v[128:143], v[180:183], a[228:231], v[128:143]
    s_nop 6
    ds_write_b128 v212, v[112:115] offset:128
    ds_write_b128 v213, v[116:119] offset:128
    v_mfma_f32_32x32x16_bf16 v[128:143], v[188:191], a[236:239], v[128:143]
    ds_write_b128 v214, v[120:123] offset:128
    ds_write_b128 v215, v[124:127] offset:128
    s_nop 9
    ds_write_b128 v212, v[128:131] offset:32896
    ds_write_b128 v213, v[132:135] offset:32896
    ds_write_b128 v214, v[136:139] offset:32896
    ds_write_b128 v215, v[140:143] offset:32896
    s_waitcnt lgkmcnt(0)
    s_barrier
    buffer_store_dword v245, v76, s[80:83], 0 offen offset:0 sc1
    ds_read_b128 v[80:83], v248 offset:0
    ds_read_b128 v[84:87], v248 offset:4096
    ds_read_b128 v[88:91], v248 offset:8192
    ds_read_b128 v[92:95], v248 offset:12288
    ds_read_b128 v[96:99], v249 offset:1024
    ds_read_b128 v[100:103], v249 offset:5120
    ds_read_b128 v[104:107], v249 offset:9216
    ds_read_b128 v[108:111], v249 offset:13312
    ds_read_b128 v[112:115], v248 offset:2048
    ds_read_b128 v[116:119], v248 offset:6144
    ds_read_b128 v[120:123], v248 offset:10240
    ds_read_b128 v[124:127], v248 offset:14336
    ds_read_b128 v[128:131], v249 offset:3072
    ds_read_b128 v[132:135], v249 offset:7168
    ds_read_b128 v[136:139], v249 offset:11264
    ds_read_b128 v[140:143], v249 offset:15360
    s_waitcnt lgkmcnt(12)
    v_pk_add_f32 v[80:81], v[80:81], v[48:49]
    v_pk_add_f32 v[82:83], v[82:83], v[50:51]
    v_pk_add_f32 v[84:85], v[84:85], v[88:89]
    v_pk_add_f32 v[86:87], v[86:87], v[90:91]
    v_pk_add_f32 v[80:81], v[80:81], v[92:93]
    v_pk_add_f32 v[82:83], v[82:83], v[94:95]
    v_pk_add_f32 v[80:81], v[80:81], v[84:85]
    v_pk_add_f32 v[82:83], v[82:83], v[86:87]
    s_mov_b32 s12, 0
    buffer_store_dwordx4 v[80:83], v75, s[88:91], s12 offen sc1
    s_waitcnt lgkmcnt(8)
    v_pk_add_f32 v[96:97], v[96:97], v[52:53]
    v_pk_add_f32 v[98:99], v[98:99], v[54:55]
    v_pk_add_f32 v[100:101], v[100:101], v[104:105]
    v_pk_add_f32 v[102:103], v[102:103], v[106:107]
    v_pk_add_f32 v[96:97], v[96:97], v[108:109]
    v_pk_add_f32 v[98:99], v[98:99], v[110:111]
    v_pk_add_f32 v[96:97], v[96:97], v[100:101]
    v_pk_add_f32 v[98:99], v[98:99], v[102:103]
    s_mov_b32 s12, 32768
    buffer_store_dwordx4 v[96:99], v75, s[88:91], s12 offen sc1
    s_waitcnt lgkmcnt(4)
    v_pk_add_f32 v[112:113], v[112:113], v[56:57]
    v_pk_add_f32 v[114:115], v[114:115], v[58:59]
    v_pk_add_f32 v[116:117], v[116:117], v[120:121]
    v_pk_add_f32 v[118:119], v[118:119], v[122:123]
    v_pk_add_f32 v[112:113], v[112:113], v[124:125]
    v_pk_add_f32 v[114:115], v[114:115], v[126:127]
    v_pk_add_f32 v[112:113], v[112:113], v[116:117]
    v_pk_add_f32 v[114:115], v[114:115], v[118:119]
    s_mov_b32 s12, 8192
    buffer_store_dwordx4 v[112:115], v75, s[88:91], s12 offen sc1
    s_waitcnt lgkmcnt(0)
    v_pk_add_f32 v[128:129], v[128:129], v[60:61]
    v_pk_add_f32 v[130:131], v[130:131], v[62:63]
    v_pk_add_f32 v[132:133], v[132:133], v[136:137]
    v_pk_add_f32 v[134:135], v[134:135], v[138:139]
    v_pk_add_f32 v[128:129], v[128:129], v[140:141]
    v_pk_add_f32 v[130:131], v[130:131], v[142:143]
    v_pk_add_f32 v[128:129], v[128:129], v[132:133]
    v_pk_add_f32 v[130:131], v[130:131], v[134:135]
    s_mov_b32 s12, 40960
    buffer_store_dwordx4 v[128:131], v75, s[88:91], s12 offen sc1
L_end:
    s_endpgm
.fill (32768+256-(.-gated_mix__ssm_conv_s5__glu_gated_swiglu__prompt_kernel))/4, 4, 0xbf810000
.section .rodata,"a"
.p2align 6
.amdhsa_kernel gated_mix__ssm_conv_s5__glu_gated_swiglu__prompt_kernel
  .amdhsa_next_free_vgpr 512
  .amdhsa_next_free_sgpr 102
  .amdhsa_accum_offset 256
  .amdhsa_group_segment_fixed_size 0
  .amdhsa_kernarg_size 136
  .amdhsa_user_sgpr_count 2
  .amdhsa_user_sgpr_kernarg_segment_ptr 1
  .amdhsa_system_sgpr_workgroup_id_x 1
.end_amdhsa_kernel
```
